```python
import torch

def _softmax(x, axis=-1):
    return torch.softmax(x, dim=axis)
def _gelu(x):
    return torch.nn.functional.gelu(x, approximate="tanh")
def _silu(x):
    return torch.nn.functional.silu(x)
def _sigmoid(x):
    return torch.sigmoid(x)
def _layernorm(x, axis=-1, eps=1e-5):
    m = x.mean(dim=axis, keepdim=True)
    v = x.var(dim=axis, keepdim=True, unbiased=False)
    return (x - m) / torch.sqrt(v + eps)
def _scatter_add(tgt, idx, src, axis=0):
    return tgt.clone().index_add_(axis, idx, src)
def _segment_sum(src, seg, n):
    out = torch.zeros((n,) + src.shape[1:], dtype=src.dtype)
    return out.index_add_(0, seg, src)
def _pad(x, pw):
    flat = tuple(v for pair in reversed(pw) for v in pair)
    return torch.nn.functional.pad(x, flat)

kernel_name = 'standalone__gqa_block_cached__near_ridge'

def setup_inputs():

    _w = (lambda a: (lambda t: t.to(torch.bfloat16) if t.is_floating_point() else t)(torch.as_tensor(a)))
    B, Sq, D = 8, 112, 512
    Hq, Hkv, Sk, Dh = 32, 32, 1024, 128
    assert Hq % Hkv == 0, (Hq, Hkv)
    return {
        "x": _w((lambda *s: torch.randn(*s, dtype=torch.bfloat16) * 0.8)(B, Sq, D)),
        "k_cache": _w((lambda *s: torch.randn(*s, dtype=torch.bfloat16) * 0.8)(B, Hkv, Sk, Dh)),
        "v_cache": _w((lambda *s: torch.randn(*s, dtype=torch.bfloat16) * 0.05)(B, Hkv, Sk, Dh)),
        "wq": _w((lambda *s: torch.randn(*s, dtype=torch.bfloat16) * 0.8)(D, Hq * Dh) * (D ** -0.5)),
        "wo": _w((lambda *s: torch.randn(*s, dtype=torch.bfloat16) * 0.05)(Hq * Dh, D) * ((Hq * Dh) ** -0.5)),
    }

def reference(x, k_cache, v_cache, wq, wo):
    B, Sq, D = x.shape
    Hq, Dh = 32, 128
    Hkv = k_cache.shape[1]
    rep = Hq // Hkv
    q = (lambda x, *d: x.permute(*d))((x @ wq).reshape(B, Sq, Hq, Dh), 0, 2, 1, 3)
    k = (lambda x, n, axis: torch.repeat_interleave(x, n, dim=axis))(k_cache, rep, axis=1)
    v = (lambda x, n, axis: torch.repeat_interleave(x, n, dim=axis))(v_cache, rep, axis=1)
    scores = torch.einsum("bhqd,bhkd->bhqk", q, k) * (Dh ** -0.5)
    p = _softmax(scores, axis=-1)
    o = torch.einsum("bhqk,bhkd->bhqd", p, v)
    return (lambda x, *d: x.permute(*d))(o, 0, 2, 1, 3).reshape(B, Sq, Hq * Dh) @ wo
```

```asm
; @launch kernel=attn_fused_kernel grid=(256,1,1) block=(512,1,1) lds=163840
; @launch kernel=oproj_kernel grid=(256,1,1) block=(512,1,1) lds=147456
.amdgcn_target "amdgcn-amd-amdhsa--gfx950"
.text
.globl attn_fused_kernel
.p2align 8
.type attn_fused_kernel,@function
attn_fused_kernel:
    s_cmp_ge_u32 s2, 256
    s_cbranch_scc1 L_attn_end
    s_load_dwordx4 s[40:43], s[0:1], 0
    s_load_dwordx4 s[44:47], s[0:1], 16
    s_load_dwordx2 s[48:49], s[0:1], 56
    v_and_b32 v1, 63, v0
    v_lshrrev_b32 v7, 6, v0
    s_nop 0
    v_readfirstlane_b32 s3, v7
    s_lshr_b32 s4, s2, 5
    s_and_b32 s5, s2, 31
    v_and_b32 v2, 31, v1
    v_lshrrev_b32 v3, 5, v1
    s_lshr_b32 s32, s3, 2
    s_and_b32 s33, s3, 3
    s_mov_b32 s36, 0x3e0293ee
    s_waitcnt lgkmcnt(0)
    s_lshl_b32 s28, s2, 18
    s_add_u32 s8, s42, s28
    s_addc_u32 s9, s43, 0
    s_mov_b32 s10, 262144
    s_mov_b32 s11, 0x00020000
    s_add_u32 s12, s44, s28
    s_addc_u32 s13, s45, 0
    s_mov_b32 s14, 262144
    s_mov_b32 s15, 0x00020000
    s_mul_i32 s28, s4, 114688
    s_add_u32 s16, s40, s28
    s_addc_u32 s17, s41, 0
    s_sub_u32 s18, 917504, s28
    s_mov_b32 s19, 0x00020000
    s_lshl_b32 s28, s5, 8
    s_add_u32 s20, s46, s28
    s_addc_u32 s21, s47, 0
    s_sub_u32 s22, 4194304, s28
    s_mov_b32 s23, 0x00020000
    s_mul_i32 s28, s4, 917504
    s_lshl_b32 s29, s5, 8
    s_add_u32 s28, s28, s29
    s_add_u32 s24, s48, s28
    s_addc_u32 s25, s49, 0
    s_sub_u32 s26, 7340032, s28
    s_mov_b32 s27, 0x00020000
    v_lshrrev_b32 v8, 4, v1
    s_lshl_b32 s31, s3, 3
    v_add_u32 v8, s31, v8
    v_and_b32 v14, 15, v1
    v_and_b32 v15, 15, v8
    v_xor_b32 v15, v15, v14
    v_lshlrev_b32 v15, 4, v15
    v_lshl_add_u32 v4, v8, 8, v15
    v_xor_b32 v5, 64, v4
    v_add_u32 v5, 1024, v5
    v_and_b32 v15, 3, v8
    v_lshlrev_b32 v15, 2, v15
    v_xor_b32 v15, v15, v14
    v_lshlrev_b32 v15, 4, v15
    v_lshl_add_u32 v6, v8, 8, v15
    v_mov_b32 v22, 0
    s_cmp_ge_u32 s3, 4
    s_cbranch_scc1 L_pro_kv
    v_lshrrev_b32 v8, 4, v1
    v_lshlrev_b32 v14, 2, v8
    v_and_b32 v15, 15, v1
    v_xor_b32 v15, v15, v14
    v_lshlrev_b32 v15, 4, v15
    v_lshl_add_u32 v16, v8, 13, v15
    v_lshrrev_b32 v8, 3, v1
    v_lshrrev_b32 v14, 1, v8
    v_and_b32 v15, 7, v1
    v_xor_b32 v15, v15, v14
    v_lshlrev_b32 v15, 4, v15
    v_lshl_add_u32 v17, v8, 10, v15
    v_xor_b32 v22, 64, v17
    s_lshl_b32 s30, s3, 12
    s_add_u32 s30, s30, 65536
    s_lshl_b32 s31, s3, 17
    s_add_u32 s31, s31, 0
    s_mov_b32 m0, s30
    s_add_u32 s30, s30, 1024
    buffer_load_dwordx4 v16, s[20:23], s31 offen lds
    s_add_u32 s31, s31, 32768
    s_mov_b32 m0, s30
    s_add_u32 s30, s30, 1024
    buffer_load_dwordx4 v16, s[20:23], s31 offen lds
    s_add_u32 s31, s31, 32768
    s_mov_b32 m0, s30
    s_add_u32 s30, s30, 1024
    buffer_load_dwordx4 v16, s[20:23], s31 offen lds
    s_add_u32 s31, s31, 32768
    s_mov_b32 m0, s30
    s_add_u32 s30, s30, 1024
    buffer_load_dwordx4 v16, s[20:23], s31 offen lds
    s_add_u32 s31, s31, 32768
    s_lshl_b32 s30, s3, 12
    s_add_u32 s30, s30, 114688
    s_lshl_b32 s31, s3, 15
    s_add_u32 s31, s31, 0
    s_mov_b32 m0, s30
    s_add_u32 s30, s30, 1024
    buffer_load_dwordx4 v17, s[16:19], s31 offen lds
    s_add_u32 s31, s31, 8192
    s_mov_b32 m0, s30
    s_add_u32 s30, s30, 1024
    buffer_load_dwordx4 v22, s[16:19], s31 offen lds
    s_add_u32 s31, s31, 8192
    s_mov_b32 m0, s30
    s_add_u32 s30, s30, 1024
    buffer_load_dwordx4 v17, s[16:19], s31 offen lds
    s_add_u32 s31, s31, 8192
    s_mov_b32 m0, s30
    s_add_u32 s30, s30, 1024
    buffer_load_dwordx4 v22, s[16:19], s31 offen lds
    s_add_u32 s31, s31, 8192
    s_lshl_b32 s30, s3, 12
    s_add_u32 s30, s30, 81920
    s_lshl_b32 s31, s3, 17
    s_add_u32 s31, s31, 524288
    s_mov_b32 m0, s30
    s_add_u32 s30, s30, 1024
    buffer_load_dwordx4 v16, s[20:23], s31 offen lds
    s_add_u32 s31, s31, 32768
    s_mov_b32 m0, s30
    s_add_u32 s30, s30, 1024
    buffer_load_dwordx4 v16, s[20:23], s31 offen lds
    s_add_u32 s31, s31, 32768
    s_mov_b32 m0, s30
    s_add_u32 s30, s30, 1024
    buffer_load_dwordx4 v16, s[20:23], s31 offen lds
    s_add_u32 s31, s31, 32768
    s_mov_b32 m0, s30
    s_add_u32 s30, s30, 1024
    buffer_load_dwordx4 v16, s[20:23], s31 offen lds
    s_add_u32 s31, s31, 32768
    s_lshl_b32 s30, s3, 12
    s_add_u32 s30, s30, 131072
    s_lshl_b32 s31, s3, 15
    s_add_u32 s31, s31, 128
    s_mov_b32 m0, s30
    s_add_u32 s30, s30, 1024
    buffer_load_dwordx4 v17, s[16:19], s31 offen lds
    s_add_u32 s31, s31, 8192
    s_mov_b32 m0, s30
    s_add_u32 s30, s30, 1024
    buffer_load_dwordx4 v22, s[16:19], s31 offen lds
    s_add_u32 s31, s31, 8192
    s_mov_b32 m0, s30
    s_add_u32 s30, s30, 1024
    buffer_load_dwordx4 v17, s[16:19], s31 offen lds
    s_add_u32 s31, s31, 8192
    s_mov_b32 m0, s30
    s_add_u32 s30, s30, 1024
    buffer_load_dwordx4 v22, s[16:19], s31 offen lds
    s_add_u32 s31, s31, 8192
    s_lshl_b32 s30, s3, 12
    s_add_u32 s30, s30, 98304
    s_lshl_b32 s31, s3, 17
    s_add_u32 s31, s31, 1048576
    s_mov_b32 m0, s30
    s_add_u32 s30, s30, 1024
    buffer_load_dwordx4 v16, s[20:23], s31 offen lds
    s_add_u32 s31, s31, 32768
    s_mov_b32 m0, s30
    s_add_u32 s30, s30, 1024
    buffer_load_dwordx4 v16, s[20:23], s31 offen lds
    s_add_u32 s31, s31, 32768
    s_mov_b32 m0, s30
    s_add_u32 s30, s30, 1024
    buffer_load_dwordx4 v16, s[20:23], s31 offen lds
    s_add_u32 s31, s31, 32768
    s_mov_b32 m0, s30
    s_add_u32 s30, s30, 1024
    buffer_load_dwordx4 v16, s[20:23], s31 offen lds
    s_add_u32 s31, s31, 32768
    s_lshl_b32 s30, s3, 12
    s_add_u32 s30, s30, 147456
    s_lshl_b32 s31, s3, 15
    s_add_u32 s31, s31, 256
    s_mov_b32 m0, s30
    s_add_u32 s30, s30, 1024
    buffer_load_dwordx4 v17, s[16:19], s31 offen lds
    s_add_u32 s31, s31, 8192
    s_mov_b32 m0, s30
    s_add_u32 s30, s30, 1024
    buffer_load_dwordx4 v22, s[16:19], s31 offen lds
    s_add_u32 s31, s31, 8192
    s_mov_b32 m0, s30
    s_add_u32 s30, s30, 1024
    buffer_load_dwordx4 v17, s[16:19], s31 offen lds
    s_add_u32 s31, s31, 8192
    s_mov_b32 m0, s30
    s_add_u32 s30, s30, 1024
    buffer_load_dwordx4 v22, s[16:19], s31 offen lds
    s_add_u32 s31, s31, 8192
    s_branch L_pro_done
L_pro_kv:
    s_sub_u32 s29, s3, 4
    s_lshl_b32 s29, s29, 1
    v_lshrrev_b32 v8, 4, v1
    s_lshl_b32 s31, s29, 3
    v_add_u32 v8, s31, v8
    v_and_b32 v14, 15, v1
    v_and_b32 v15, 15, v8
    v_xor_b32 v15, v15, v14
    v_lshlrev_b32 v15, 4, v15
    v_lshl_add_u32 v16, v8, 8, v15
    v_xor_b32 v17, 64, v16
    v_add_u32 v17, 1024, v17
    v_and_b32 v15, 3, v8
    v_lshlrev_b32 v15, 2, v15
    v_xor_b32 v15, v15, v14
    v_lshlrev_b32 v15, 4, v15
    v_lshl_add_u32 v18, v8, 8, v15
    s_lshl_b32 s30, s29, 11
    s_add_u32 s30, s30, 0
    s_mov_b32 s31, 0
    s_mov_b32 m0, s30
    s_add_u32 s30, s30, 1024
    buffer_load_dwordx4 v16, s[8:11], s31 offen lds
    s_mov_b32 m0, s30
    s_add_u32 s30, s30, 15360
    buffer_load_dwordx4 v17, s[8:11], s31 offen lds
    s_mov_b32 m0, s30
    s_nop 0
    buffer_load_dwordx4 v18, s[12:15], s31 offen lds
    buffer_load_dwordx4 v18, s[12:15], s31 offen offset:1024 lds
    s_lshl_b32 s30, s29, 11
    s_add_u32 s30, s30, 32768
    s_mov_b32 s31, 16384
    s_mov_b32 m0, s30
    s_add_u32 s30, s30, 1024
    buffer_load_dwordx4 v16, s[8:11], s31 offen lds
    s_mov_b32 m0, s30
    s_add_u32 s30, s30, 15360
    buffer_load_dwordx4 v17, s[8:11], s31 offen lds
    s_mov_b32 m0, s30
    s_nop 0
    buffer_load_dwordx4 v18, s[12:15], s31 offen lds
    buffer_load_dwordx4 v18, s[12:15], s31 offen offset:1024 lds
    s_sub_u32 s29, s3, 4
    s_lshl_b32 s29, s29, 1
    s_add_u32 s29, s29, 1
    v_lshrrev_b32 v8, 4, v1
    s_lshl_b32 s31, s29, 3
    v_add_u32 v8, s31, v8
    v_and_b32 v14, 15, v1
    v_and_b32 v15, 15, v8
    v_xor_b32 v15, v15, v14
    v_lshlrev_b32 v15, 4, v15
    v_lshl_add_u32 v16, v8, 8, v15
    v_xor_b32 v17, 64, v16
    v_add_u32 v17, 1024, v17
    v_and_b32 v15, 3, v8
    v_lshlrev_b32 v15, 2, v15
    v_xor_b32 v15, v15, v14
    v_lshlrev_b32 v15, 4, v15
    v_lshl_add_u32 v18, v8, 8, v15
    s_lshl_b32 s30, s29, 11
    s_add_u32 s30, s30, 0
    s_mov_b32 s31, 0
    s_mov_b32 m0, s30
    s_add_u32 s30, s30, 1024
    buffer_load_dwordx4 v16, s[8:11], s31 offen lds
    s_mov_b32 m0, s30
    s_add_u32 s30, s30, 15360
    buffer_load_dwordx4 v17, s[8:11], s31 offen lds
    s_mov_b32 m0, s30
    s_nop 0
    buffer_load_dwordx4 v18, s[12:15], s31 offen lds
    buffer_load_dwordx4 v18, s[12:15], s31 offen offset:1024 lds
    s_lshl_b32 s30, s29, 11
    s_add_u32 s30, s30, 32768
    s_mov_b32 s31, 16384
    s_mov_b32 m0, s30
    s_add_u32 s30, s30, 1024
    buffer_load_dwordx4 v16, s[8:11], s31 offen lds
    s_mov_b32 m0, s30
    s_add_u32 s30, s30, 15360
    buffer_load_dwordx4 v17, s[8:11], s31 offen lds
    s_mov_b32 m0, s30
    s_nop 0
    buffer_load_dwordx4 v18, s[12:15], s31 offen lds
    buffer_load_dwordx4 v18, s[12:15], s31 offen offset:1024 lds
L_pro_done:
    v_and_b32 v8, 15, v1
    v_lshrrev_b32 v14, 2, v8
    v_and_b32 v8, 3, v8
    v_lshlrev_b32 v8, 3, v8
    v_lshl_add_u32 v8, v14, 8, v8
    v_lshl_add_u32 v8, v14, 6, v8
    v_lshl_add_u32 v8, v3, 11, v8
    v_bfe_u32 v14, v1, 4, 1
    v_lshl_add_u32 v8, v14, 5, v8
    s_lshl_b32 s28, s32, 7
    v_xor_b32 v19, s28, v8
    v_add_u32 v19, 0x10000, v19
    v_xor_b32 v20, 64, v19
    s_lshl_b32 s28, s33, 5
    v_add_u32 v8, s28, v2
    v_bfe_u32 v14, v8, 1, 3
    v_xor_b32 v14, v14, v3
    v_lshlrev_b32 v14, 4, v14
    v_lshl_add_u32 v21, v8, 7, v14
    v_add_u32 v21, 0x1c000, v21
    s_cmp_ge_u32 s3, 4
    s_cbranch_scc1 L_qw0
    s_waitcnt vmcnt(16)
    s_branch L_qx0
L_qw0:
L_qx0:
    s_barrier
    v_xor_b32 v7, 0, v21
    ds_read_b128 v[84:87], v7 offset:0
    v_xor_b32 v7, 32, v21
    ds_read_b128 v[88:91], v7 offset:0
    v_xor_b32 v7, 64, v21
    ds_read_b128 v[92:95], v7 offset:0
    v_xor_b32 v7, 96, v21
    ds_read_b128 v[96:99], v7 offset:0
    ds_read_b64_tr_b16 v[244:245], v19 offset:0
    ds_read_b64_tr_b16 v[246:247], v19 offset:1024
    ds_read_b64_tr_b16 v[248:249], v20 offset:0
    ds_read_b64_tr_b16 v[250:251], v20 offset:1024
    s_waitcnt lgkmcnt(2)
    v_mfma_f32_32x32x16_bf16 v[212:227], v[244:247], v[84:87], 0
    s_waitcnt lgkmcnt(0)
    v_mfma_f32_32x32x16_bf16 v[228:243], v[248:251], v[84:87], 0
    ds_read_b64_tr_b16 v[244:245], v19 offset:4096
    ds_read_b64_tr_b16 v[246:247], v19 offset:5120
    ds_read_b64_tr_b16 v[248:249], v20 offset:4096
    ds_read_b64_tr_b16 v[250:251], v20 offset:5120
    s_waitcnt lgkmcnt(2)
    v_mfma_f32_32x32x16_bf16 v[212:227], v[244:247], v[88:91], v[212:227]
    s_waitcnt lgkmcnt(0)
    v_mfma_f32_32x32x16_bf16 v[228:243], v[248:251], v[88:91], v[228:243]
    ds_read_b64_tr_b16 v[244:245], v19 offset:8192
    ds_read_b64_tr_b16 v[246:247], v19 offset:9216
    ds_read_b64_tr_b16 v[248:249], v20 offset:8192
    ds_read_b64_tr_b16 v[250:251], v20 offset:9216
    s_waitcnt lgkmcnt(2)
    v_mfma_f32_32x32x16_bf16 v[212:227], v[244:247], v[92:95], v[212:227]
    s_waitcnt lgkmcnt(0)
    v_mfma_f32_32x32x16_bf16 v[228:243], v[248:251], v[92:95], v[228:243]
    ds_read_b64_tr_b16 v[244:245], v19 offset:12288
    ds_read_b64_tr_b16 v[246:247], v19 offset:13312
    ds_read_b64_tr_b16 v[248:249], v20 offset:12288
    ds_read_b64_tr_b16 v[250:251], v20 offset:13312
    s_waitcnt lgkmcnt(2)
    v_mfma_f32_32x32x16_bf16 v[212:227], v[244:247], v[96:99], v[212:227]
    s_waitcnt lgkmcnt(0)
    v_mfma_f32_32x32x16_bf16 v[228:243], v[248:251], v[96:99], v[228:243]
    s_barrier
    s_cmp_ge_u32 s3, 4
    s_cbranch_scc1 L_qi0
    s_lshl_b32 s30, s3, 12
    s_add_u32 s30, s30, 65536
    s_lshl_b32 s31, s3, 17
    s_add_u32 s31, s31, 1572864
    s_mov_b32 m0, s30
    s_add_u32 s30, s30, 1024
    buffer_load_dwordx4 v16, s[20:23], s31 offen lds
    s_add_u32 s31, s31, 32768
    s_mov_b32 m0, s30
    s_add_u32 s30, s30, 1024
    buffer_load_dwordx4 v16, s[20:23], s31 offen lds
    s_add_u32 s31, s31, 32768
    s_mov_b32 m0, s30
    s_add_u32 s30, s30, 1024
    buffer_load_dwordx4 v16, s[20:23], s31 offen lds
    s_add_u32 s31, s31, 32768
    s_mov_b32 m0, s30
    s_add_u32 s30, s30, 1024
    buffer_load_dwordx4 v16, s[20:23], s31 offen lds
    s_add_u32 s31, s31, 32768
    s_lshl_b32 s30, s3, 12
    s_add_u32 s30, s30, 114688
    s_lshl_b32 s31, s3, 15
    s_add_u32 s31, s31, 384
    s_mov_b32 m0, s30
    s_add_u32 s30, s30, 1024
    buffer_load_dwordx4 v17, s[16:19], s31 offen lds
    s_add_u32 s31, s31, 8192
    s_mov_b32 m0, s30
    s_add_u32 s30, s30, 1024
    buffer_load_dwordx4 v22, s[16:19], s31 offen lds
    s_add_u32 s31, s31, 8192
    s_mov_b32 m0, s30
    s_add_u32 s30, s30, 1024
    buffer_load_dwordx4 v17, s[16:19], s31 offen lds
    s_add_u32 s31, s31, 8192
    s_mov_b32 m0, s30
    s_add_u32 s30, s30, 1024
    buffer_load_dwordx4 v22, s[16:19], s31 offen lds
    s_add_u32 s31, s31, 8192
L_qi0:
    s_cmp_ge_u32 s3, 4
    s_cbranch_scc1 L_qw1
    s_waitcnt vmcnt(16)
    s_branch L_qx1
L_qw1:
L_qx1:
    s_barrier
    v_xor_b32 v7, 0, v21
    ds_read_b128 v[84:87], v7 offset:16384
    v_xor_b32 v7, 32, v21
    ds_read_b128 v[88:91], v7 offset:16384
    v_xor_b32 v7, 64, v21
    ds_read_b128 v[92:95], v7 offset:16384
    v_xor_b32 v7, 96, v21
    ds_read_b128 v[96:99], v7 offset:16384
    ds_read_b64_tr_b16 v[244:245], v19 offset:16384
    ds_read_b64_tr_b16 v[246:247], v19 offset:17408
    ds_read_b64_tr_b16 v[248:249], v20 offset:16384
    ds_read_b64_tr_b16 v[250:251], v20 offset:17408
    s_waitcnt lgkmcnt(2)
    v_mfma_f32_32x32x16_bf16 v[212:227], v[244:247], v[84:87], v[212:227]
    s_waitcnt lgkmcnt(0)
    v_mfma_f32_32x32x16_bf16 v[228:243], v[248:251], v[84:87], v[228:243]
    ds_read_b64_tr_b16 v[244:245], v19 offset:20480
    ds_read_b64_tr_b16 v[246:247], v19 offset:21504
    ds_read_b64_tr_b16 v[248:249], v20 offset:20480
    ds_read_b64_tr_b16 v[250:251], v20 offset:21504
    s_waitcnt lgkmcnt(2)
    v_mfma_f32_32x32x16_bf16 v[212:227], v[244:247], v[88:91], v[212:227]
    s_waitcnt lgkmcnt(0)
    v_mfma_f32_32x32x16_bf16 v[228:243], v[248:251], v[88:91], v[228:243]
    ds_read_b64_tr_b16 v[244:245], v19 offset:24576
    ds_read_b64_tr_b16 v[246:247], v19 offset:25600
    ds_read_b64_tr_b16 v[248:249], v20 offset:24576
    ds_read_b64_tr_b16 v[250:251], v20 offset:25600
    s_waitcnt lgkmcnt(2)
    v_mfma_f32_32x32x16_bf16 v[212:227], v[244:247], v[92:95], v[212:227]
    s_waitcnt lgkmcnt(0)
    v_mfma_f32_32x32x16_bf16 v[228:243], v[248:251], v[92:95], v[228:243]
    ds_read_b64_tr_b16 v[244:245], v19 offset:28672
    ds_read_b64_tr_b16 v[246:247], v19 offset:29696
    ds_read_b64_tr_b16 v[248:249], v20 offset:28672
    ds_read_b64_tr_b16 v[250:251], v20 offset:29696
    s_waitcnt lgkmcnt(2)
    v_mfma_f32_32x32x16_bf16 v[212:227], v[244:247], v[96:99], v[212:227]
    s_waitcnt lgkmcnt(0)
    v_mfma_f32_32x32x16_bf16 v[228:243], v[248:251], v[96:99], v[228:243]
    s_barrier
    s_cmp_ge_u32 s3, 4
    s_cbranch_scc1 L_qi1
    s_lshl_b32 s30, s3, 12
    s_add_u32 s30, s30, 81920
    s_lshl_b32 s31, s3, 17
    s_add_u32 s31, s31, 2097152
    s_mov_b32 m0, s30
    s_add_u32 s30, s30, 1024
    buffer_load_dwordx4 v16, s[20:23], s31 offen lds
    s_add_u32 s31, s31, 32768
    s_mov_b32 m0, s30
    s_add_u32 s30, s30, 1024
    buffer_load_dwordx4 v16, s[20:23], s31 offen lds
    s_add_u32 s31, s31, 32768
    s_mov_b32 m0, s30
    s_add_u32 s30, s30, 1024
    buffer_load_dwordx4 v16, s[20:23], s31 offen lds
    s_add_u32 s31, s31, 32768
    s_mov_b32 m0, s30
    s_add_u32 s30, s30, 1024
    buffer_load_dwordx4 v16, s[20:23], s31 offen lds
    s_add_u32 s31, s31, 32768
    s_lshl_b32 s30, s3, 12
    s_add_u32 s30, s30, 131072
    s_lshl_b32 s31, s3, 15
    s_add_u32 s31, s31, 512
    s_mov_b32 m0, s30
    s_add_u32 s30, s30, 1024
    buffer_load_dwordx4 v17, s[16:19], s31 offen lds
    s_add_u32 s31, s31, 8192
    s_mov_b32 m0, s30
    s_add_u32 s30, s30, 1024
    buffer_load_dwordx4 v22, s[16:19], s31 offen lds
    s_add_u32 s31, s31, 8192
    s_mov_b32 m0, s30
    s_add_u32 s30, s30, 1024
    buffer_load_dwordx4 v17, s[16:19], s31 offen lds
    s_add_u32 s31, s31, 8192
    s_mov_b32 m0, s30
    s_add_u32 s30, s30, 1024
    buffer_load_dwordx4 v22, s[16:19], s31 offen lds
    s_add_u32 s31, s31, 8192
L_qi1:
    s_cmp_ge_u32 s3, 4
    s_cbranch_scc1 L_qw2
    s_waitcnt vmcnt(16)
    s_branch L_qx2
L_qw2:
L_qx2:
    s_barrier
    v_xor_b32 v7, 0, v21
    ds_read_b128 v[84:87], v7 offset:32768
    v_xor_b32 v7, 32, v21
    ds_read_b128 v[88:91], v7 offset:32768
    v_xor_b32 v7, 64, v21
    ds_read_b128 v[92:95], v7 offset:32768
    v_xor_b32 v7, 96, v21
    ds_read_b128 v[96:99], v7 offset:32768
    ds_read_b64_tr_b16 v[244:245], v19 offset:32768
    ds_read_b64_tr_b16 v[246:247], v19 offset:33792
    ds_read_b64_tr_b16 v[248:249], v20 offset:32768
    ds_read_b64_tr_b16 v[250:251], v20 offset:33792
    s_waitcnt lgkmcnt(2)
    v_mfma_f32_32x32x16_bf16 v[212:227], v[244:247], v[84:87], v[212:227]
    s_waitcnt lgkmcnt(0)
    v_mfma_f32_32x32x16_bf16 v[228:243], v[248:251], v[84:87], v[228:243]
    ds_read_b64_tr_b16 v[244:245], v19 offset:36864
    ds_read_b64_tr_b16 v[246:247], v19 offset:37888
    ds_read_b64_tr_b16 v[248:249], v20 offset:36864
    ds_read_b64_tr_b16 v[250:251], v20 offset:37888
    s_waitcnt lgkmcnt(2)
    v_mfma_f32_32x32x16_bf16 v[212:227], v[244:247], v[88:91], v[212:227]
    s_waitcnt lgkmcnt(0)
    v_mfma_f32_32x32x16_bf16 v[228:243], v[248:251], v[88:91], v[228:243]
    ds_read_b64_tr_b16 v[244:245], v19 offset:40960
    ds_read_b64_tr_b16 v[246:247], v19 offset:41984
    ds_read_b64_tr_b16 v[248:249], v20 offset:40960
    ds_read_b64_tr_b16 v[250:251], v20 offset:41984
    s_waitcnt lgkmcnt(2)
    v_mfma_f32_32x32x16_bf16 v[212:227], v[244:247], v[92:95], v[212:227]
    s_waitcnt lgkmcnt(0)
    v_mfma_f32_32x32x16_bf16 v[228:243], v[248:251], v[92:95], v[228:243]
    ds_read_b64_tr_b16 v[244:245], v19 offset:45056
    ds_read_b64_tr_b16 v[246:247], v19 offset:46080
    ds_read_b64_tr_b16 v[248:249], v20 offset:45056
    ds_read_b64_tr_b16 v[250:251], v20 offset:46080
    s_waitcnt lgkmcnt(2)
    v_mfma_f32_32x32x16_bf16 v[212:227], v[244:247], v[96:99], v[212:227]
    s_waitcnt lgkmcnt(0)
    v_mfma_f32_32x32x16_bf16 v[228:243], v[248:251], v[96:99], v[228:243]
    s_barrier
    s_cmp_ge_u32 s3, 4
    s_cbranch_scc1 L_qi2
    s_lshl_b32 s30, s3, 12
    s_add_u32 s30, s30, 98304
    s_lshl_b32 s31, s3, 17
    s_add_u32 s31, s31, 2621440
    s_mov_b32 m0, s30
    s_add_u32 s30, s30, 1024
    buffer_load_dwordx4 v16, s[20:23], s31 offen lds
    s_add_u32 s31, s31, 32768
    s_mov_b32 m0, s30
    s_add_u32 s30, s30, 1024
    buffer_load_dwordx4 v16, s[20:23], s31 offen lds
    s_add_u32 s31, s31, 32768
    s_mov_b32 m0, s30
    s_add_u32 s30, s30, 1024
    buffer_load_dwordx4 v16, s[20:23], s31 offen lds
    s_add_u32 s31, s31, 32768
    s_mov_b32 m0, s30
    s_add_u32 s30, s30, 1024
    buffer_load_dwordx4 v16, s[20:23], s31 offen lds
    s_add_u32 s31, s31, 32768
    s_lshl_b32 s30, s3, 12
    s_add_u32 s30, s30, 147456
    s_lshl_b32 s31, s3, 15
    s_add_u32 s31, s31, 640
    s_mov_b32 m0, s30
    s_add_u32 s30, s30, 1024
    buffer_load_dwordx4 v17, s[16:19], s31 offen lds
    s_add_u32 s31, s31, 8192
    s_mov_b32 m0, s30
    s_add_u32 s30, s30, 1024
    buffer_load_dwordx4 v22, s[16:19], s31 offen lds
    s_add_u32 s31, s31, 8192
    s_mov_b32 m0, s30
    s_add_u32 s30, s30, 1024
    buffer_load_dwordx4 v17, s[16:19], s31 offen lds
    s_add_u32 s31, s31, 8192
    s_mov_b32 m0, s30
    s_add_u32 s30, s30, 1024
    buffer_load_dwordx4 v22, s[16:19], s31 offen lds
    s_add_u32 s31, s31, 8192
L_qi2:
    s_cmp_ge_u32 s3, 4
    s_cbranch_scc1 L_qw3
    s_waitcnt vmcnt(16)
    s_branch L_qx3
L_qw3:
L_qx3:
    s_barrier
    v_xor_b32 v7, 0, v21
    ds_read_b128 v[84:87], v7 offset:0
    v_xor_b32 v7, 32, v21
    ds_read_b128 v[88:91], v7 offset:0
    v_xor_b32 v7, 64, v21
    ds_read_b128 v[92:95], v7 offset:0
    v_xor_b32 v7, 96, v21
    ds_read_b128 v[96:99], v7 offset:0
    ds_read_b64_tr_b16 v[244:245], v19 offset:0
    ds_read_b64_tr_b16 v[246:247], v19 offset:1024
    ds_read_b64_tr_b16 v[248:249], v20 offset:0
    ds_read_b64_tr_b16 v[250:251], v20 offset:1024
    s_waitcnt lgkmcnt(2)
    v_mfma_f32_32x32x16_bf16 v[212:227], v[244:247], v[84:87], v[212:227]
    s_waitcnt lgkmcnt(0)
    v_mfma_f32_32x32x16_bf16 v[228:243], v[248:251], v[84:87], v[228:243]
    ds_read_b64_tr_b16 v[244:245], v19 offset:4096
    ds_read_b64_tr_b16 v[246:247], v19 offset:5120
    ds_read_b64_tr_b16 v[248:249], v20 offset:4096
    ds_read_b64_tr_b16 v[250:251], v20 offset:5120
    s_waitcnt lgkmcnt(2)
    v_mfma_f32_32x32x16_bf16 v[212:227], v[244:247], v[88:91], v[212:227]
    s_waitcnt lgkmcnt(0)
    v_mfma_f32_32x32x16_bf16 v[228:243], v[248:251], v[88:91], v[228:243]
    ds_read_b64_tr_b16 v[244:245], v19 offset:8192
    ds_read_b64_tr_b16 v[246:247], v19 offset:9216
    ds_read_b64_tr_b16 v[248:249], v20 offset:8192
    ds_read_b64_tr_b16 v[250:251], v20 offset:9216
    s_waitcnt lgkmcnt(2)
    v_mfma_f32_32x32x16_bf16 v[212:227], v[244:247], v[92:95], v[212:227]
    s_waitcnt lgkmcnt(0)
    v_mfma_f32_32x32x16_bf16 v[228:243], v[248:251], v[92:95], v[228:243]
    ds_read_b64_tr_b16 v[244:245], v19 offset:12288
    ds_read_b64_tr_b16 v[246:247], v19 offset:13312
    ds_read_b64_tr_b16 v[248:249], v20 offset:12288
    ds_read_b64_tr_b16 v[250:251], v20 offset:13312
    s_waitcnt lgkmcnt(2)
    v_mfma_f32_32x32x16_bf16 v[212:227], v[244:247], v[96:99], v[212:227]
    s_waitcnt lgkmcnt(0)
    v_mfma_f32_32x32x16_bf16 v[228:243], v[248:251], v[96:99], v[228:243]
    s_barrier
    s_cmp_ge_u32 s3, 4
    s_cbranch_scc1 L_qi3
    s_lshl_b32 s30, s3, 12
    s_add_u32 s30, s30, 65536
    s_lshl_b32 s31, s3, 17
    s_add_u32 s31, s31, 3145728
    s_mov_b32 m0, s30
    s_add_u32 s30, s30, 1024
    buffer_load_dwordx4 v16, s[20:23], s31 offen lds
    s_add_u32 s31, s31, 32768
    s_mov_b32 m0, s30
    s_add_u32 s30, s30, 1024
    buffer_load_dwordx4 v16, s[20:23], s31 offen lds
    s_add_u32 s31, s31, 32768
    s_mov_b32 m0, s30
    s_add_u32 s30, s30, 1024
    buffer_load_dwordx4 v16, s[20:23], s31 offen lds
    s_add_u32 s31, s31, 32768
    s_mov_b32 m0, s30
    s_add_u32 s30, s30, 1024
    buffer_load_dwordx4 v16, s[20:23], s31 offen lds
    s_add_u32 s31, s31, 32768
    s_lshl_b32 s30, s3, 12
    s_add_u32 s30, s30, 114688
    s_lshl_b32 s31, s3, 15
    s_add_u32 s31, s31, 768
    s_mov_b32 m0, s30
    s_add_u32 s30, s30, 1024
    buffer_load_dwordx4 v17, s[16:19], s31 offen lds
    s_add_u32 s31, s31, 8192
    s_mov_b32 m0, s30
    s_add_u32 s30, s30, 1024
    buffer_load_dwordx4 v22, s[16:19], s31 offen lds
    s_add_u32 s31, s31, 8192
    s_mov_b32 m0, s30
    s_add_u32 s30, s30, 1024
    buffer_load_dwordx4 v17, s[16:19], s31 offen lds
    s_add_u32 s31, s31, 8192
    s_mov_b32 m0, s30
    s_add_u32 s30, s30, 1024
    buffer_load_dwordx4 v22, s[16:19], s31 offen lds
    s_add_u32 s31, s31, 8192
L_qi3:
    s_cmp_ge_u32 s3, 4
    s_cbranch_scc1 L_qw4
    s_waitcnt vmcnt(16)
    s_branch L_qx4
L_qw4:
L_qx4:
    s_barrier
    v_xor_b32 v7, 0, v21
    ds_read_b128 v[84:87], v7 offset:16384
    v_xor_b32 v7, 32, v21
    ds_read_b128 v[88:91], v7 offset:16384
    v_xor_b32 v7, 64, v21
    ds_read_b128 v[92:95], v7 offset:16384
    v_xor_b32 v7, 96, v21
    ds_read_b128 v[96:99], v7 offset:16384
    ds_read_b64_tr_b16 v[244:245], v19 offset:16384
    ds_read_b64_tr_b16 v[246:247], v19 offset:17408
    ds_read_b64_tr_b16 v[248:249], v20 offset:16384
    ds_read_b64_tr_b16 v[250:251], v20 offset:17408
    s_waitcnt lgkmcnt(2)
    v_mfma_f32_32x32x16_bf16 v[212:227], v[244:247], v[84:87], v[212:227]
    s_waitcnt lgkmcnt(0)
    v_mfma_f32_32x32x16_bf16 v[228:243], v[248:251], v[84:87], v[228:243]
    ds_read_b64_tr_b16 v[244:245], v19 offset:20480
    ds_read_b64_tr_b16 v[246:247], v19 offset:21504
    ds_read_b64_tr_b16 v[248:249], v20 offset:20480
    ds_read_b64_tr_b16 v[250:251], v20 offset:21504
    s_waitcnt lgkmcnt(2)
    v_mfma_f32_32x32x16_bf16 v[212:227], v[244:247], v[88:91], v[212:227]
    s_waitcnt lgkmcnt(0)
    v_mfma_f32_32x32x16_bf16 v[228:243], v[248:251], v[88:91], v[228:243]
    ds_read_b64_tr_b16 v[244:245], v19 offset:24576
    ds_read_b64_tr_b16 v[246:247], v19 offset:25600
    ds_read_b64_tr_b16 v[248:249], v20 offset:24576
    ds_read_b64_tr_b16 v[250:251], v20 offset:25600
    s_waitcnt lgkmcnt(2)
    v_mfma_f32_32x32x16_bf16 v[212:227], v[244:247], v[92:95], v[212:227]
    s_waitcnt lgkmcnt(0)
    v_mfma_f32_32x32x16_bf16 v[228:243], v[248:251], v[92:95], v[228:243]
    ds_read_b64_tr_b16 v[244:245], v19 offset:28672
    ds_read_b64_tr_b16 v[246:247], v19 offset:29696
    ds_read_b64_tr_b16 v[248:249], v20 offset:28672
    ds_read_b64_tr_b16 v[250:251], v20 offset:29696
    s_waitcnt lgkmcnt(2)
    v_mfma_f32_32x32x16_bf16 v[212:227], v[244:247], v[96:99], v[212:227]
    s_waitcnt lgkmcnt(0)
    v_mfma_f32_32x32x16_bf16 v[228:243], v[248:251], v[96:99], v[228:243]
    s_barrier
    s_cmp_ge_u32 s3, 4
    s_cbranch_scc1 L_qi4
    s_lshl_b32 s30, s3, 12
    s_add_u32 s30, s30, 81920
    s_lshl_b32 s31, s3, 17
    s_add_u32 s31, s31, 3670016
    s_mov_b32 m0, s30
    s_add_u32 s30, s30, 1024
    buffer_load_dwordx4 v16, s[20:23], s31 offen lds
    s_add_u32 s31, s31, 32768
    s_mov_b32 m0, s30
    s_add_u32 s30, s30, 1024
    buffer_load_dwordx4 v16, s[20:23], s31 offen lds
    s_add_u32 s31, s31, 32768
    s_mov_b32 m0, s30
    s_add_u32 s30, s30, 1024
    buffer_load_dwordx4 v16, s[20:23], s31 offen lds
    s_add_u32 s31, s31, 32768
    s_mov_b32 m0, s30
    s_add_u32 s30, s30, 1024
    buffer_load_dwordx4 v16, s[20:23], s31 offen lds
    s_add_u32 s31, s31, 32768
    s_lshl_b32 s30, s3, 12
    s_add_u32 s30, s30, 131072
    s_lshl_b32 s31, s3, 15
    s_add_u32 s31, s31, 896
    s_mov_b32 m0, s30
    s_add_u32 s30, s30, 1024
    buffer_load_dwordx4 v17, s[16:19], s31 offen lds
    s_add_u32 s31, s31, 8192
    s_mov_b32 m0, s30
    s_add_u32 s30, s30, 1024
    buffer_load_dwordx4 v22, s[16:19], s31 offen lds
    s_add_u32 s31, s31, 8192
    s_mov_b32 m0, s30
    s_add_u32 s30, s30, 1024
    buffer_load_dwordx4 v17, s[16:19], s31 offen lds
    s_add_u32 s31, s31, 8192
    s_mov_b32 m0, s30
    s_add_u32 s30, s30, 1024
    buffer_load_dwordx4 v22, s[16:19], s31 offen lds
    s_add_u32 s31, s31, 8192
L_qi4:
    s_cmp_ge_u32 s3, 4
    s_cbranch_scc1 L_qw5
    s_waitcnt vmcnt(16)
    s_branch L_qx5
L_qw5:
L_qx5:
    s_barrier
    v_xor_b32 v7, 0, v21
    ds_read_b128 v[84:87], v7 offset:32768
    v_xor_b32 v7, 32, v21
    ds_read_b128 v[88:91], v7 offset:32768
    v_xor_b32 v7, 64, v21
    ds_read_b128 v[92:95], v7 offset:32768
    v_xor_b32 v7, 96, v21
    ds_read_b128 v[96:99], v7 offset:32768
    ds_read_b64_tr_b16 v[244:245], v19 offset:32768
    ds_read_b64_tr_b16 v[246:247], v19 offset:33792
    ds_read_b64_tr_b16 v[248:249], v20 offset:32768
    ds_read_b64_tr_b16 v[250:251], v20 offset:33792
    s_waitcnt lgkmcnt(2)
    v_mfma_f32_32x32x16_bf16 v[212:227], v[244:247], v[84:87], v[212:227]
    s_waitcnt lgkmcnt(0)
    v_mfma_f32_32x32x16_bf16 v[228:243], v[248:251], v[84:87], v[228:243]
    ds_read_b64_tr_b16 v[244:245], v19 offset:36864
    ds_read_b64_tr_b16 v[246:247], v19 offset:37888
    ds_read_b64_tr_b16 v[248:249], v20 offset:36864
    ds_read_b64_tr_b16 v[250:251], v20 offset:37888
    s_waitcnt lgkmcnt(2)
    v_mfma_f32_32x32x16_bf16 v[212:227], v[244:247], v[88:91], v[212:227]
    s_waitcnt lgkmcnt(0)
    v_mfma_f32_32x32x16_bf16 v[228:243], v[248:251], v[88:91], v[228:243]
    ds_read_b64_tr_b16 v[244:245], v19 offset:40960
    ds_read_b64_tr_b16 v[246:247], v19 offset:41984
    ds_read_b64_tr_b16 v[248:249], v20 offset:40960
    ds_read_b64_tr_b16 v[250:251], v20 offset:41984
    s_waitcnt lgkmcnt(2)
    v_mfma_f32_32x32x16_bf16 v[212:227], v[244:247], v[92:95], v[212:227]
    s_waitcnt lgkmcnt(0)
    v_mfma_f32_32x32x16_bf16 v[228:243], v[248:251], v[92:95], v[228:243]
    ds_read_b64_tr_b16 v[244:245], v19 offset:45056
    ds_read_b64_tr_b16 v[246:247], v19 offset:46080
    ds_read_b64_tr_b16 v[248:249], v20 offset:45056
    ds_read_b64_tr_b16 v[250:251], v20 offset:46080
    s_waitcnt lgkmcnt(2)
    v_mfma_f32_32x32x16_bf16 v[212:227], v[244:247], v[96:99], v[212:227]
    s_waitcnt lgkmcnt(0)
    v_mfma_f32_32x32x16_bf16 v[228:243], v[248:251], v[96:99], v[228:243]
    s_cmp_ge_u32 s3, 4
    s_cbranch_scc1 L_qw6
    s_waitcnt vmcnt(8)
    s_branch L_qx6
L_qw6:
L_qx6:
    s_barrier
    v_xor_b32 v7, 0, v21
    ds_read_b128 v[84:87], v7 offset:0
    v_xor_b32 v7, 32, v21
    ds_read_b128 v[88:91], v7 offset:0
    v_xor_b32 v7, 64, v21
    ds_read_b128 v[92:95], v7 offset:0
    v_xor_b32 v7, 96, v21
    ds_read_b128 v[96:99], v7 offset:0
    ds_read_b64_tr_b16 v[244:245], v19 offset:0
    ds_read_b64_tr_b16 v[246:247], v19 offset:1024
    ds_read_b64_tr_b16 v[248:249], v20 offset:0
    ds_read_b64_tr_b16 v[250:251], v20 offset:1024
    s_waitcnt lgkmcnt(2)
    v_mfma_f32_32x32x16_bf16 v[212:227], v[244:247], v[84:87], v[212:227]
    s_waitcnt lgkmcnt(0)
    v_mfma_f32_32x32x16_bf16 v[228:243], v[248:251], v[84:87], v[228:243]
    ds_read_b64_tr_b16 v[244:245], v19 offset:4096
    ds_read_b64_tr_b16 v[246:247], v19 offset:5120
    ds_read_b64_tr_b16 v[248:249], v20 offset:4096
    ds_read_b64_tr_b16 v[250:251], v20 offset:5120
    s_waitcnt lgkmcnt(2)
    v_mfma_f32_32x32x16_bf16 v[212:227], v[244:247], v[88:91], v[212:227]
    s_waitcnt lgkmcnt(0)
    v_mfma_f32_32x32x16_bf16 v[228:243], v[248:251], v[88:91], v[228:243]
    ds_read_b64_tr_b16 v[244:245], v19 offset:8192
    ds_read_b64_tr_b16 v[246:247], v19 offset:9216
    ds_read_b64_tr_b16 v[248:249], v20 offset:8192
    ds_read_b64_tr_b16 v[250:251], v20 offset:9216
    s_waitcnt lgkmcnt(2)
    v_mfma_f32_32x32x16_bf16 v[212:227], v[244:247], v[92:95], v[212:227]
    s_waitcnt lgkmcnt(0)
    v_mfma_f32_32x32x16_bf16 v[228:243], v[248:251], v[92:95], v[228:243]
    ds_read_b64_tr_b16 v[244:245], v19 offset:12288
    ds_read_b64_tr_b16 v[246:247], v19 offset:13312
    ds_read_b64_tr_b16 v[248:249], v20 offset:12288
    ds_read_b64_tr_b16 v[250:251], v20 offset:13312
    s_waitcnt lgkmcnt(2)
    v_mfma_f32_32x32x16_bf16 v[212:227], v[244:247], v[96:99], v[212:227]
    s_waitcnt lgkmcnt(0)
    v_mfma_f32_32x32x16_bf16 v[228:243], v[248:251], v[96:99], v[228:243]
    s_cmp_ge_u32 s3, 4
    s_cbranch_scc1 L_qw7
    s_waitcnt vmcnt(0)
    s_branch L_qx7
L_qw7:
L_qx7:
    s_barrier
    v_xor_b32 v7, 0, v21
    ds_read_b128 v[84:87], v7 offset:16384
    v_xor_b32 v7, 32, v21
    ds_read_b128 v[88:91], v7 offset:16384
    v_xor_b32 v7, 64, v21
    ds_read_b128 v[92:95], v7 offset:16384
    v_xor_b32 v7, 96, v21
    ds_read_b128 v[96:99], v7 offset:16384
    ds_read_b64_tr_b16 v[244:245], v19 offset:16384
    ds_read_b64_tr_b16 v[246:247], v19 offset:17408
    ds_read_b64_tr_b16 v[248:249], v20 offset:16384
    ds_read_b64_tr_b16 v[250:251], v20 offset:17408
    s_waitcnt lgkmcnt(2)
    v_mfma_f32_32x32x16_bf16 v[212:227], v[244:247], v[84:87], v[212:227]
    s_waitcnt lgkmcnt(0)
    v_mfma_f32_32x32x16_bf16 v[228:243], v[248:251], v[84:87], v[228:243]
    ds_read_b64_tr_b16 v[244:245], v19 offset:20480
    ds_read_b64_tr_b16 v[246:247], v19 offset:21504
    ds_read_b64_tr_b16 v[248:249], v20 offset:20480
    ds_read_b64_tr_b16 v[250:251], v20 offset:21504
    s_waitcnt lgkmcnt(2)
    v_mfma_f32_32x32x16_bf16 v[212:227], v[244:247], v[88:91], v[212:227]
    s_waitcnt lgkmcnt(0)
    v_mfma_f32_32x32x16_bf16 v[228:243], v[248:251], v[88:91], v[228:243]
    ds_read_b64_tr_b16 v[244:245], v19 offset:24576
    ds_read_b64_tr_b16 v[246:247], v19 offset:25600
    ds_read_b64_tr_b16 v[248:249], v20 offset:24576
    ds_read_b64_tr_b16 v[250:251], v20 offset:25600
    s_waitcnt lgkmcnt(2)
    v_mfma_f32_32x32x16_bf16 v[212:227], v[244:247], v[92:95], v[212:227]
    s_waitcnt lgkmcnt(0)
    v_mfma_f32_32x32x16_bf16 v[228:243], v[248:251], v[92:95], v[228:243]
    ds_read_b64_tr_b16 v[244:245], v19 offset:28672
    ds_read_b64_tr_b16 v[246:247], v19 offset:29696
    ds_read_b64_tr_b16 v[248:249], v20 offset:28672
    ds_read_b64_tr_b16 v[250:251], v20 offset:29696
    s_waitcnt lgkmcnt(2)
    v_mfma_f32_32x32x16_bf16 v[212:227], v[244:247], v[96:99], v[212:227]
    s_waitcnt lgkmcnt(0)
    v_mfma_f32_32x32x16_bf16 v[228:243], v[248:251], v[96:99], v[228:243]
    s_barrier
    s_lshl_b32 s30, s3, 11
    s_add_u32 s30, s30, 65536
    s_mov_b32 s31, 32768
    s_mov_b32 m0, s30
    s_add_u32 s30, s30, 1024
    buffer_load_dwordx4 v4, s[8:11], s31 offen lds
    s_mov_b32 m0, s30
    s_add_u32 s30, s30, 15360
    buffer_load_dwordx4 v5, s[8:11], s31 offen lds
    s_mov_b32 m0, s30
    s_nop 0
    buffer_load_dwordx4 v6, s[12:15], s31 offen lds
    buffer_load_dwordx4 v6, s[12:15], s31 offen offset:1024 lds
    s_nop 7
    s_nop 7
    s_lshl_b32 s28, s33, 5
    v_add_u32 v8, s28, v2
    v_and_b32 v14, 15, v8
    v_lshlrev_b32 v14, 4, v14
    v_lshl_add_u32 v8, v8, 8, v14
    v_lshl_add_u32 v8, v3, 3, v8
    s_lshl_b32 s28, s32, 7
    v_xor_b32 v8, s28, v8
    v_add_u32 v8, 0x20000, v8
    v_cvt_pk_bf16_f32 v14, v212, v213
    v_cvt_pk_bf16_f32 v15, v214, v215
    v_xor_b32 v7, 0, v8
    ds_write_b64 v7, v[14:15]
    v_cvt_pk_bf16_f32 v14, v216, v217
    v_cvt_pk_bf16_f32 v15, v218, v219
    v_xor_b32 v7, 16, v8
    ds_write_b64 v7, v[14:15]
    v_cvt_pk_bf16_f32 v14, v220, v221
    v_cvt_pk_bf16_f32 v15, v222, v223
    v_xor_b32 v7, 32, v8
    ds_write_b64 v7, v[14:15]
    v_cvt_pk_bf16_f32 v14, v224, v225
    v_cvt_pk_bf16_f32 v15, v226, v227
    v_xor_b32 v7, 48, v8
    ds_write_b64 v7, v[14:15]
    v_cvt_pk_bf16_f32 v14, v228, v229
    v_cvt_pk_bf16_f32 v15, v230, v231
    v_xor_b32 v7, 64, v8
    ds_write_b64 v7, v[14:15]
    v_cvt_pk_bf16_f32 v14, v232, v233
    v_cvt_pk_bf16_f32 v15, v234, v235
    v_xor_b32 v7, 80, v8
    ds_write_b64 v7, v[14:15]
    v_cvt_pk_bf16_f32 v14, v236, v237
    v_cvt_pk_bf16_f32 v15, v238, v239
    v_xor_b32 v7, 96, v8
    ds_write_b64 v7, v[14:15]
    v_cvt_pk_bf16_f32 v14, v240, v241
    v_cvt_pk_bf16_f32 v15, v242, v243
    v_xor_b32 v7, 112, v8
    ds_write_b64 v7, v[14:15]
    s_waitcnt lgkmcnt(0)
    s_barrier
    s_lshl_b32 s28, s33, 5
    v_add_u32 v8, s28, v2
    v_and_b32 v14, 15, v8
    v_xor_b32 v14, v14, v3
    v_lshlrev_b32 v14, 4, v14
    v_lshl_add_u32 v8, v8, 8, v14
    v_add_u32 v8, 0x20000, v8
    v_xor_b32 v7, 0, v8
    ds_read_b128 v[28:31], v7
    v_xor_b32 v7, 32, v8
    ds_read_b128 v[32:35], v7
    v_xor_b32 v7, 64, v8
    ds_read_b128 v[36:39], v7
    v_xor_b32 v7, 96, v8
    ds_read_b128 v[40:43], v7
    v_xor_b32 v7, 128, v8
    ds_read_b128 v[44:47], v7
    v_xor_b32 v7, 160, v8
    ds_read_b128 v[48:51], v7
    v_xor_b32 v7, 192, v8
    ds_read_b128 v[52:55], v7
    v_xor_b32 v7, 224, v8
    ds_read_b128 v[56:59], v7
    s_lshl_b32 s28, s32, 5
    v_add_u32 v8, s28, v2
    v_and_b32 v14, 15, v8
    v_xor_b32 v14, v14, v3
    v_lshlrev_b32 v14, 4, v14
    v_lshl_add_u32 v8, v8, 8, v14
    v_xor_b32 v16, 0, v8
    v_xor_b32 v17, 32, v8
    v_xor_b32 v18, 64, v8
    v_xor_b32 v19, 96, v8
    v_xor_b32 v20, 128, v8
    v_xor_b32 v21, 160, v8
    v_xor_b32 v22, 192, v8
    v_xor_b32 v23, 224, v8
    v_and_b32 v8, 15, v1
    v_lshrrev_b32 v14, 2, v8
    v_and_b32 v8, 3, v8
    v_lshlrev_b32 v8, 3, v8
    v_lshl_add_u32 v8, v14, 8, v8
    v_lshl_add_u32 v8, v14, 6, v8
    v_lshl_add_u32 v8, v3, 10, v8
    v_bfe_u32 v14, v1, 4, 1
    v_lshl_add_u32 v8, v14, 5, v8
    s_lshl_b32 s28, s32, 13
    v_add_u32 v8, s28, v8
    v_xor_b32 v24, 0, v8
    v_xor_b32 v25, 64, v8
    v_xor_b32 v26, 128, v8
    v_xor_b32 v27, 192, v8
    v_mov_b32 v11, 0xf149f2ca
    v_mov_b32 v12, 0
    v_mov_b32 v148, 0
    v_mov_b32 v149, 0
    v_mov_b32 v150, 0
    v_mov_b32 v151, 0
    v_mov_b32 v152, 0
    v_mov_b32 v153, 0
    v_mov_b32 v154, 0
    v_mov_b32 v155, 0
    v_mov_b32 v156, 0
    v_mov_b32 v157, 0
    v_mov_b32 v158, 0
    v_mov_b32 v159, 0
    v_mov_b32 v160, 0
    v_mov_b32 v161, 0
    v_mov_b32 v162, 0
    v_mov_b32 v163, 0
    v_mov_b32 v164, 0
    v_mov_b32 v165, 0
    v_mov_b32 v166, 0
    v_mov_b32 v167, 0
    v_mov_b32 v168, 0
    v_mov_b32 v169, 0
    v_mov_b32 v170, 0
    v_mov_b32 v171, 0
    v_mov_b32 v172, 0
    v_mov_b32 v173, 0
    v_mov_b32 v174, 0
    v_mov_b32 v175, 0
    v_mov_b32 v176, 0
    v_mov_b32 v177, 0
    v_mov_b32 v178, 0
    v_mov_b32 v179, 0
    v_mov_b32 v180, 0
    v_mov_b32 v181, 0
    v_mov_b32 v182, 0
    v_mov_b32 v183, 0
    v_mov_b32 v184, 0
    v_mov_b32 v185, 0
    v_mov_b32 v186, 0
    v_mov_b32 v187, 0
    v_mov_b32 v188, 0
    v_mov_b32 v189, 0
    v_mov_b32 v190, 0
    v_mov_b32 v191, 0
    v_mov_b32 v192, 0
    v_mov_b32 v193, 0
    v_mov_b32 v194, 0
    v_mov_b32 v195, 0
    v_mov_b32 v196, 0
    v_mov_b32 v197, 0
    v_mov_b32 v198, 0
    v_mov_b32 v199, 0
    v_mov_b32 v200, 0
    v_mov_b32 v201, 0
    v_mov_b32 v202, 0
    v_mov_b32 v203, 0
    v_mov_b32 v204, 0
    v_mov_b32 v205, 0
    v_mov_b32 v206, 0
    v_mov_b32 v207, 0
    v_mov_b32 v208, 0
    v_mov_b32 v209, 0
    v_mov_b32 v210, 0
    v_mov_b32 v211, 0
    s_waitcnt lgkmcnt(0)
    s_waitcnt vmcnt(12)
    s_barrier
    s_lshl_b32 s30, s3, 11
    s_add_u32 s30, s30, 98304
    s_mov_b32 s31, 49152
    s_mov_b32 m0, s30
    s_add_u32 s30, s30, 1024
    buffer_load_dwordx4 v4, s[8:11], s31 offen lds
    s_mov_b32 m0, s30
    s_add_u32 s30, s30, 15360
    buffer_load_dwordx4 v5, s[8:11], s31 offen lds
    s_mov_b32 m0, s30
    s_nop 0
    buffer_load_dwordx4 v6, s[12:15], s31 offen lds
    buffer_load_dwordx4 v6, s[12:15], s31 offen offset:1024 lds
    ds_read_b128 v[84:87], v16 offset:0
    ds_read_b128 v[88:91], v17 offset:0
    ds_read_b128 v[92:95], v18 offset:0
    ds_read_b128 v[96:99], v19 offset:0
    ds_read_b128 v[100:103], v20 offset:0
    ds_read_b128 v[104:107], v21 offset:0
    ds_read_b128 v[108:111], v22 offset:0
    ds_read_b128 v[112:115], v23 offset:0
    s_waitcnt lgkmcnt(7)
    v_mfma_f32_32x32x16_bf16 v[60:75], v[84:87], v[28:31], 0
    s_waitcnt lgkmcnt(6)
    v_mfma_f32_32x32x16_bf16 v[60:75], v[88:91], v[32:35], v[60:75]
    s_waitcnt lgkmcnt(5)
    v_mfma_f32_32x32x16_bf16 v[60:75], v[92:95], v[36:39], v[60:75]
    s_waitcnt lgkmcnt(4)
    v_mfma_f32_32x32x16_bf16 v[60:75], v[96:99], v[40:43], v[60:75]
    s_waitcnt lgkmcnt(3)
    v_mfma_f32_32x32x16_bf16 v[60:75], v[100:103], v[44:47], v[60:75]
    s_waitcnt lgkmcnt(2)
    v_mfma_f32_32x32x16_bf16 v[60:75], v[104:107], v[48:51], v[60:75]
    s_waitcnt lgkmcnt(1)
    v_mfma_f32_32x32x16_bf16 v[60:75], v[108:111], v[52:55], v[60:75]
    s_waitcnt lgkmcnt(0)
    v_mfma_f32_32x32x16_bf16 v[60:75], v[112:115], v[56:59], v[60:75]
    ds_read_b64_tr_b16 v[116:117], v24 offset:16384
    ds_read_b64_tr_b16 v[118:119], v24 offset:18432
    ds_read_b64_tr_b16 v[120:121], v25 offset:16384
    ds_read_b64_tr_b16 v[122:123], v25 offset:18432
    ds_read_b64_tr_b16 v[124:125], v26 offset:16384
    ds_read_b64_tr_b16 v[126:127], v26 offset:18432
    ds_read_b64_tr_b16 v[128:129], v27 offset:16384
    ds_read_b64_tr_b16 v[130:131], v27 offset:18432
    ds_read_b64_tr_b16 v[132:133], v24 offset:20480
    ds_read_b64_tr_b16 v[134:135], v24 offset:22528
    ds_read_b64_tr_b16 v[136:137], v25 offset:20480
    ds_read_b64_tr_b16 v[138:139], v25 offset:22528
    ds_read_b64_tr_b16 v[140:141], v26 offset:20480
    ds_read_b64_tr_b16 v[142:143], v26 offset:22528
    ds_read_b64_tr_b16 v[144:145], v27 offset:20480
    ds_read_b64_tr_b16 v[146:147], v27 offset:22528
    s_nop 7
    s_nop 3
    v_max3_f32 v7, v60, v61, v62
    v_max3_f32 v7, v7, v63, v64
    v_max3_f32 v7, v7, v65, v66
    v_max3_f32 v7, v7, v67, v68
    v_max3_f32 v7, v7, v69, v70
    v_max3_f32 v7, v7, v71, v72
    v_max3_f32 v7, v7, v73, v74
    v_max_f32 v7, v7, v75
    v_mov_b32 v8, v7
    s_nop 1
    v_permlane32_swap_b32 v7, v8
    v_max_f32 v7, v7, v8
    v_mul_f32 v7, s36, v7
    v_max_f32 v7, v7, v11
    v_sub_f32 v13, v11, v7
    v_exp_f32 v13, v13
    v_mov_b32 v11, v7
    v_fma_f32 v60, v60, s36, -v11
    v_exp_f32 v60, v60
    v_fma_f32 v61, v61, s36, -v11
    v_exp_f32 v61, v61
    v_fma_f32 v62, v62, s36, -v11
    v_exp_f32 v62, v62
    v_fma_f32 v63, v63, s36, -v11
    v_exp_f32 v63, v63
    v_fma_f32 v64, v64, s36, -v11
    v_exp_f32 v64, v64
    v_fma_f32 v65, v65, s36, -v11
    v_exp_f32 v65, v65
    v_fma_f32 v66, v66, s36, -v11
    v_exp_f32 v66, v66
    v_fma_f32 v67, v67, s36, -v11
    v_exp_f32 v67, v67
    v_fma_f32 v68, v68, s36, -v11
    v_exp_f32 v68, v68
    v_fma_f32 v69, v69, s36, -v11
    v_exp_f32 v69, v69
    v_fma_f32 v70, v70, s36, -v11
    v_exp_f32 v70, v70
    v_fma_f32 v71, v71, s36, -v11
    v_exp_f32 v71, v71
    v_fma_f32 v72, v72, s36, -v11
    v_exp_f32 v72, v72
    v_fma_f32 v73, v73, s36, -v11
    v_exp_f32 v73, v73
    v_fma_f32 v74, v74, s36, -v11
    v_exp_f32 v74, v74
    v_fma_f32 v75, v75, s36, -v11
    v_exp_f32 v75, v75
    v_mul_f32 v12, v12, v13
    v_add_f32 v12, v12, v60
    v_add_f32 v12, v12, v61
    v_add_f32 v12, v12, v62
    v_add_f32 v12, v12, v63
    v_add_f32 v12, v12, v64
    v_add_f32 v12, v12, v65
    v_add_f32 v12, v12, v66
    v_add_f32 v12, v12, v67
    v_add_f32 v12, v12, v68
    v_add_f32 v12, v12, v69
    v_add_f32 v12, v12, v70
    v_add_f32 v12, v12, v71
    v_add_f32 v12, v12, v72
    v_add_f32 v12, v12, v73
    v_add_f32 v12, v12, v74
    v_add_f32 v12, v12, v75
    v_cvt_pk_bf16_f32 v76, v60, v61
    v_cvt_pk_bf16_f32 v77, v62, v63
    v_cvt_pk_bf16_f32 v78, v64, v65
    v_cvt_pk_bf16_f32 v79, v66, v67
    v_cvt_pk_bf16_f32 v80, v68, v69
    v_cvt_pk_bf16_f32 v81, v70, v71
    v_cvt_pk_bf16_f32 v82, v72, v73
    v_cvt_pk_bf16_f32 v83, v74, v75
    v_mul_f32 v148, v13, v148
    v_mul_f32 v149, v13, v149
    v_mul_f32 v150, v13, v150
    v_mul_f32 v151, v13, v151
    v_mul_f32 v152, v13, v152
    v_mul_f32 v153, v13, v153
    v_mul_f32 v154, v13, v154
    v_mul_f32 v155, v13, v155
    v_mul_f32 v156, v13, v156
    v_mul_f32 v157, v13, v157
    v_mul_f32 v158, v13, v158
    v_mul_f32 v159, v13, v159
    v_mul_f32 v160, v13, v160
    v_mul_f32 v161, v13, v161
    v_mul_f32 v162, v13, v162
    v_mul_f32 v163, v13, v163
    v_mul_f32 v164, v13, v164
    v_mul_f32 v165, v13, v165
    v_mul_f32 v166, v13, v166
    v_mul_f32 v167, v13, v167
    v_mul_f32 v168, v13, v168
    v_mul_f32 v169, v13, v169
    v_mul_f32 v170, v13, v170
    v_mul_f32 v171, v13, v171
    v_mul_f32 v172, v13, v172
    v_mul_f32 v173, v13, v173
    v_mul_f32 v174, v13, v174
    v_mul_f32 v175, v13, v175
    v_mul_f32 v176, v13, v176
    v_mul_f32 v177, v13, v177
    v_mul_f32 v178, v13, v178
    v_mul_f32 v179, v13, v179
    v_mul_f32 v180, v13, v180
    v_mul_f32 v181, v13, v181
    v_mul_f32 v182, v13, v182
    v_mul_f32 v183, v13, v183
    v_mul_f32 v184, v13, v184
    v_mul_f32 v185, v13, v185
    v_mul_f32 v186, v13, v186
    v_mul_f32 v187, v13, v187
    v_mul_f32 v188, v13, v188
    v_mul_f32 v189, v13, v189
    v_mul_f32 v190, v13, v190
    v_mul_f32 v191, v13, v191
    v_mul_f32 v192, v13, v192
    v_mul_f32 v193, v13, v193
    v_mul_f32 v194, v13, v194
    v_mul_f32 v195, v13, v195
    v_mul_f32 v196, v13, v196
    v_mul_f32 v197, v13, v197
    v_mul_f32 v198, v13, v198
    v_mul_f32 v199, v13, v199
    v_mul_f32 v200, v13, v200
    v_mul_f32 v201, v13, v201
    v_mul_f32 v202, v13, v202
    v_mul_f32 v203, v13, v203
    v_mul_f32 v204, v13, v204
    v_mul_f32 v205, v13, v205
    v_mul_f32 v206, v13, v206
    v_mul_f32 v207, v13, v207
    v_mul_f32 v208, v13, v208
    v_mul_f32 v209, v13, v209
    v_mul_f32 v210, v13, v210
    v_mul_f32 v211, v13, v211
    s_waitcnt lgkmcnt(0)
    v_mfma_f32_32x32x16_bf16 v[148:163], v[116:119], v[76:79], v[148:163]
    v_mfma_f32_32x32x16_bf16 v[164:179], v[120:123], v[76:79], v[164:179]
    v_mfma_f32_32x32x16_bf16 v[180:195], v[124:127], v[76:79], v[180:195]
    v_mfma_f32_32x32x16_bf16 v[196:211], v[128:131], v[76:79], v[196:211]
    v_mfma_f32_32x32x16_bf16 v[148:163], v[132:135], v[80:83], v[148:163]
    v_mfma_f32_32x32x16_bf16 v[164:179], v[136:139], v[80:83], v[164:179]
    v_mfma_f32_32x32x16_bf16 v[180:195], v[140:143], v[80:83], v[180:195]
    v_mfma_f32_32x32x16_bf16 v[196:211], v[144:147], v[80:83], v[196:211]
    s_waitcnt vmcnt(8)
    s_barrier
    s_lshl_b32 s30, s3, 11
    s_add_u32 s30, s30, 0
    s_mov_b32 s31, 65536
    s_mov_b32 m0, s30
    s_add_u32 s30, s30, 1024
    buffer_load_dwordx4 v4, s[8:11], s31 offen lds
    s_mov_b32 m0, s30
    s_add_u32 s30, s30, 15360
    buffer_load_dwordx4 v5, s[8:11], s31 offen lds
    s_mov_b32 m0, s30
    s_nop 0
    buffer_load_dwordx4 v6, s[12:15], s31 offen lds
    buffer_load_dwordx4 v6, s[12:15], s31 offen offset:1024 lds
    ds_read_b128 v[84:87], v16 offset:32768
    ds_read_b128 v[88:91], v17 offset:32768
    ds_read_b128 v[92:95], v18 offset:32768
    ds_read_b128 v[96:99], v19 offset:32768
    ds_read_b128 v[100:103], v20 offset:32768
    ds_read_b128 v[104:107], v21 offset:32768
    ds_read_b128 v[108:111], v22 offset:32768
    ds_read_b128 v[112:115], v23 offset:32768
    s_waitcnt lgkmcnt(7)
    v_mfma_f32_32x32x16_bf16 v[60:75], v[84:87], v[28:31], 0
    s_waitcnt lgkmcnt(6)
    v_mfma_f32_32x32x16_bf16 v[60:75], v[88:91], v[32:35], v[60:75]
    s_waitcnt lgkmcnt(5)
    v_mfma_f32_32x32x16_bf16 v[60:75], v[92:95], v[36:39], v[60:75]
    s_waitcnt lgkmcnt(4)
    v_mfma_f32_32x32x16_bf16 v[60:75], v[96:99], v[40:43], v[60:75]
    s_waitcnt lgkmcnt(3)
    v_mfma_f32_32x32x16_bf16 v[60:75], v[100:103], v[44:47], v[60:75]
    s_waitcnt lgkmcnt(2)
    v_mfma_f32_32x32x16_bf16 v[60:75], v[104:107], v[48:51], v[60:75]
    s_waitcnt lgkmcnt(1)
    v_mfma_f32_32x32x16_bf16 v[60:75], v[108:111], v[52:55], v[60:75]
    s_waitcnt lgkmcnt(0)
    v_mfma_f32_32x32x16_bf16 v[60:75], v[112:115], v[56:59], v[60:75]
    ds_read_b64_tr_b16 v[116:117], v24 offset:49152
    ds_read_b64_tr_b16 v[118:119], v24 offset:51200
    ds_read_b64_tr_b16 v[120:121], v25 offset:49152
    ds_read_b64_tr_b16 v[122:123], v25 offset:51200
    ds_read_b64_tr_b16 v[124:125], v26 offset:49152
    ds_read_b64_tr_b16 v[126:127], v26 offset:51200
    ds_read_b64_tr_b16 v[128:129], v27 offset:49152
    ds_read_b64_tr_b16 v[130:131], v27 offset:51200
    ds_read_b64_tr_b16 v[132:133], v24 offset:53248
    ds_read_b64_tr_b16 v[134:135], v24 offset:55296
    ds_read_b64_tr_b16 v[136:137], v25 offset:53248
    ds_read_b64_tr_b16 v[138:139], v25 offset:55296
    ds_read_b64_tr_b16 v[140:141], v26 offset:53248
    ds_read_b64_tr_b16 v[142:143], v26 offset:55296
    ds_read_b64_tr_b16 v[144:145], v27 offset:53248
    ds_read_b64_tr_b16 v[146:147], v27 offset:55296
    s_nop 7
    s_nop 3
    v_max3_f32 v7, v60, v61, v62
    v_max3_f32 v7, v7, v63, v64
    v_max3_f32 v7, v7, v65, v66
    v_max3_f32 v7, v7, v67, v68
    v_max3_f32 v7, v7, v69, v70
    v_max3_f32 v7, v7, v71, v72
    v_max3_f32 v7, v7, v73, v74
    v_max_f32 v7, v7, v75
    v_mov_b32 v8, v7
    s_nop 1
    v_permlane32_swap_b32 v7, v8
    v_max_f32 v7, v7, v8
    v_mul_f32 v7, s36, v7
    v_max_f32 v7, v7, v11
    v_sub_f32 v13, v11, v7
    v_exp_f32 v13, v13
    v_mov_b32 v11, v7
    v_fma_f32 v60, v60, s36, -v11
    v_exp_f32 v60, v60
    v_fma_f32 v61, v61, s36, -v11
    v_exp_f32 v61, v61
    v_fma_f32 v62, v62, s36, -v11
    v_exp_f32 v62, v62
    v_fma_f32 v63, v63, s36, -v11
    v_exp_f32 v63, v63
    v_fma_f32 v64, v64, s36, -v11
    v_exp_f32 v64, v64
    v_fma_f32 v65, v65, s36, -v11
    v_exp_f32 v65, v65
    v_fma_f32 v66, v66, s36, -v11
    v_exp_f32 v66, v66
    v_fma_f32 v67, v67, s36, -v11
    v_exp_f32 v67, v67
    v_fma_f32 v68, v68, s36, -v11
    v_exp_f32 v68, v68
    v_fma_f32 v69, v69, s36, -v11
    v_exp_f32 v69, v69
    v_fma_f32 v70, v70, s36, -v11
    v_exp_f32 v70, v70
    v_fma_f32 v71, v71, s36, -v11
    v_exp_f32 v71, v71
    v_fma_f32 v72, v72, s36, -v11
    v_exp_f32 v72, v72
    v_fma_f32 v73, v73, s36, -v11
    v_exp_f32 v73, v73
    v_fma_f32 v74, v74, s36, -v11
    v_exp_f32 v74, v74
    v_fma_f32 v75, v75, s36, -v11
    v_exp_f32 v75, v75
    v_mul_f32 v12, v12, v13
    v_add_f32 v12, v12, v60
    v_add_f32 v12, v12, v61
    v_add_f32 v12, v12, v62
    v_add_f32 v12, v12, v63
    v_add_f32 v12, v12, v64
    v_add_f32 v12, v12, v65
    v_add_f32 v12, v12, v66
    v_add_f32 v12, v12, v67
    v_add_f32 v12, v12, v68
    v_add_f32 v12, v12, v69
    v_add_f32 v12, v12, v70
    v_add_f32 v12, v12, v71
    v_add_f32 v12, v12, v72
    v_add_f32 v12, v12, v73
    v_add_f32 v12, v12, v74
    v_add_f32 v12, v12, v75
    v_cvt_pk_bf16_f32 v76, v60, v61
    v_cvt_pk_bf16_f32 v77, v62, v63
    v_cvt_pk_bf16_f32 v78, v64, v65
    v_cvt_pk_bf16_f32 v79, v66, v67
    v_cvt_pk_bf16_f32 v80, v68, v69
    v_cvt_pk_bf16_f32 v81, v70, v71
    v_cvt_pk_bf16_f32 v82, v72, v73
    v_cvt_pk_bf16_f32 v83, v74, v75
    v_mul_f32 v148, v13, v148
    v_mul_f32 v149, v13, v149
    v_mul_f32 v150, v13, v150
    v_mul_f32 v151, v13, v151
    v_mul_f32 v152, v13, v152
    v_mul_f32 v153, v13, v153
    v_mul_f32 v154, v13, v154
    v_mul_f32 v155, v13, v155
    v_mul_f32 v156, v13, v156
    v_mul_f32 v157, v13, v157
    v_mul_f32 v158, v13, v158
    v_mul_f32 v159, v13, v159
    v_mul_f32 v160, v13, v160
    v_mul_f32 v161, v13, v161
    v_mul_f32 v162, v13, v162
    v_mul_f32 v163, v13, v163
    v_mul_f32 v164, v13, v164
    v_mul_f32 v165, v13, v165
    v_mul_f32 v166, v13, v166
    v_mul_f32 v167, v13, v167
    v_mul_f32 v168, v13, v168
    v_mul_f32 v169, v13, v169
    v_mul_f32 v170, v13, v170
    v_mul_f32 v171, v13, v171
    v_mul_f32 v172, v13, v172
    v_mul_f32 v173, v13, v173
    v_mul_f32 v174, v13, v174
    v_mul_f32 v175, v13, v175
    v_mul_f32 v176, v13, v176
    v_mul_f32 v177, v13, v177
    v_mul_f32 v178, v13, v178
    v_mul_f32 v179, v13, v179
    v_mul_f32 v180, v13, v180
    v_mul_f32 v181, v13, v181
    v_mul_f32 v182, v13, v182
    v_mul_f32 v183, v13, v183
    v_mul_f32 v184, v13, v184
    v_mul_f32 v185, v13, v185
    v_mul_f32 v186, v13, v186
    v_mul_f32 v187, v13, v187
    v_mul_f32 v188, v13, v188
    v_mul_f32 v189, v13, v189
    v_mul_f32 v190, v13, v190
    v_mul_f32 v191, v13, v191
    v_mul_f32 v192, v13, v192
    v_mul_f32 v193, v13, v193
    v_mul_f32 v194, v13, v194
    v_mul_f32 v195, v13, v195
    v_mul_f32 v196, v13, v196
    v_mul_f32 v197, v13, v197
    v_mul_f32 v198, v13, v198
    v_mul_f32 v199, v13, v199
    v_mul_f32 v200, v13, v200
    v_mul_f32 v201, v13, v201
    v_mul_f32 v202, v13, v202
    v_mul_f32 v203, v13, v203
    v_mul_f32 v204, v13, v204
    v_mul_f32 v205, v13, v205
    v_mul_f32 v206, v13, v206
    v_mul_f32 v207, v13, v207
    v_mul_f32 v208, v13, v208
    v_mul_f32 v209, v13, v209
    v_mul_f32 v210, v13, v210
    v_mul_f32 v211, v13, v211
    s_waitcnt lgkmcnt(0)
    v_mfma_f32_32x32x16_bf16 v[148:163], v[116:119], v[76:79], v[148:163]
    v_mfma_f32_32x32x16_bf16 v[164:179], v[120:123], v[76:79], v[164:179]
    v_mfma_f32_32x32x16_bf16 v[180:195], v[124:127], v[76:79], v[180:195]
    v_mfma_f32_32x32x16_bf16 v[196:211], v[128:131], v[76:79], v[196:211]
    v_mfma_f32_32x32x16_bf16 v[148:163], v[132:135], v[80:83], v[148:163]
    v_mfma_f32_32x32x16_bf16 v[164:179], v[136:139], v[80:83], v[164:179]
    v_mfma_f32_32x32x16_bf16 v[180:195], v[140:143], v[80:83], v[180:195]
    v_mfma_f32_32x32x16_bf16 v[196:211], v[144:147], v[80:83], v[196:211]
    s_waitcnt vmcnt(8)
    s_barrier
    s_lshl_b32 s30, s3, 11
    s_add_u32 s30, s30, 32768
    s_mov_b32 s31, 81920
    s_mov_b32 m0, s30
    s_add_u32 s30, s30, 1024
    buffer_load_dwordx4 v4, s[8:11], s31 offen lds
    s_mov_b32 m0, s30
    s_add_u32 s30, s30, 15360
    buffer_load_dwordx4 v5, s[8:11], s31 offen lds
    s_mov_b32 m0, s30
    s_nop 0
    buffer_load_dwordx4 v6, s[12:15], s31 offen lds
    buffer_load_dwordx4 v6, s[12:15], s31 offen offset:1024 lds
    v_add_u32 v16, 0x10000, v16
    v_add_u32 v17, 0x10000, v17
    v_add_u32 v18, 0x10000, v18
    v_add_u32 v19, 0x10000, v19
    v_add_u32 v20, 0x10000, v20
    v_add_u32 v21, 0x10000, v21
    v_add_u32 v22, 0x10000, v22
    v_add_u32 v23, 0x10000, v23
    v_add_u32 v24, 0x10000, v24
    v_add_u32 v25, 0x10000, v25
    v_add_u32 v26, 0x10000, v26
    v_add_u32 v27, 0x10000, v27
    ds_read_b128 v[84:87], v16 offset:0
    ds_read_b128 v[88:91], v17 offset:0
    ds_read_b128 v[92:95], v18 offset:0
    ds_read_b128 v[96:99], v19 offset:0
    ds_read_b128 v[100:103], v20 offset:0
    ds_read_b128 v[104:107], v21 offset:0
    ds_read_b128 v[108:111], v22 offset:0
    ds_read_b128 v[112:115], v23 offset:0
    s_waitcnt lgkmcnt(7)
    v_mfma_f32_32x32x16_bf16 v[60:75], v[84:87], v[28:31], 0
    s_waitcnt lgkmcnt(6)
    v_mfma_f32_32x32x16_bf16 v[60:75], v[88:91], v[32:35], v[60:75]
    s_waitcnt lgkmcnt(5)
    v_mfma_f32_32x32x16_bf16 v[60:75], v[92:95], v[36:39], v[60:75]
    s_waitcnt lgkmcnt(4)
    v_mfma_f32_32x32x16_bf16 v[60:75], v[96:99], v[40:43], v[60:75]
    s_waitcnt lgkmcnt(3)
    v_mfma_f32_32x32x16_bf16 v[60:75], v[100:103], v[44:47], v[60:75]
    s_waitcnt lgkmcnt(2)
    v_mfma_f32_32x32x16_bf16 v[60:75], v[104:107], v[48:51], v[60:75]
    s_waitcnt lgkmcnt(1)
    v_mfma_f32_32x32x16_bf16 v[60:75], v[108:111], v[52:55], v[60:75]
    s_waitcnt lgkmcnt(0)
    v_mfma_f32_32x32x16_bf16 v[60:75], v[112:115], v[56:59], v[60:75]
    ds_read_b64_tr_b16 v[116:117], v24 offset:16384
    ds_read_b64_tr_b16 v[118:119], v24 offset:18432
    ds_read_b64_tr_b16 v[120:121], v25 offset:16384
    ds_read_b64_tr_b16 v[122:123], v25 offset:18432
    ds_read_b64_tr_b16 v[124:125], v26 offset:16384
    ds_read_b64_tr_b16 v[126:127], v26 offset:18432
    ds_read_b64_tr_b16 v[128:129], v27 offset:16384
    ds_read_b64_tr_b16 v[130:131], v27 offset:18432
    ds_read_b64_tr_b16 v[132:133], v24 offset:20480
    ds_read_b64_tr_b16 v[134:135], v24 offset:22528
    ds_read_b64_tr_b16 v[136:137], v25 offset:20480
    ds_read_b64_tr_b16 v[138:139], v25 offset:22528
    ds_read_b64_tr_b16 v[140:141], v26 offset:20480
    ds_read_b64_tr_b16 v[142:143], v26 offset:22528
    ds_read_b64_tr_b16 v[144:145], v27 offset:20480
    ds_read_b64_tr_b16 v[146:147], v27 offset:22528
    s_nop 7
    s_nop 3
    v_max3_f32 v7, v60, v61, v62
    v_max3_f32 v7, v7, v63, v64
    v_max3_f32 v7, v7, v65, v66
    v_max3_f32 v7, v7, v67, v68
    v_max3_f32 v7, v7, v69, v70
    v_max3_f32 v7, v7, v71, v72
    v_max3_f32 v7, v7, v73, v74
    v_max_f32 v7, v7, v75
    v_mov_b32 v8, v7
    s_nop 1
    v_permlane32_swap_b32 v7, v8
    v_max_f32 v7, v7, v8
    v_mul_f32 v7, s36, v7
    v_max_f32 v7, v7, v11
    v_sub_f32 v13, v11, v7
    v_exp_f32 v13, v13
    v_mov_b32 v11, v7
    v_fma_f32 v60, v60, s36, -v11
    v_exp_f32 v60, v60
    v_fma_f32 v61, v61, s36, -v11
    v_exp_f32 v61, v61
    v_fma_f32 v62, v62, s36, -v11
    v_exp_f32 v62, v62
    v_fma_f32 v63, v63, s36, -v11
    v_exp_f32 v63, v63
    v_fma_f32 v64, v64, s36, -v11
    v_exp_f32 v64, v64
    v_fma_f32 v65, v65, s36, -v11
    v_exp_f32 v65, v65
    v_fma_f32 v66, v66, s36, -v11
    v_exp_f32 v66, v66
    v_fma_f32 v67, v67, s36, -v11
    v_exp_f32 v67, v67
    v_fma_f32 v68, v68, s36, -v11
    v_exp_f32 v68, v68
    v_fma_f32 v69, v69, s36, -v11
    v_exp_f32 v69, v69
    v_fma_f32 v70, v70, s36, -v11
    v_exp_f32 v70, v70
    v_fma_f32 v71, v71, s36, -v11
    v_exp_f32 v71, v71
    v_fma_f32 v72, v72, s36, -v11
    v_exp_f32 v72, v72
    v_fma_f32 v73, v73, s36, -v11
    v_exp_f32 v73, v73
    v_fma_f32 v74, v74, s36, -v11
    v_exp_f32 v74, v74
    v_fma_f32 v75, v75, s36, -v11
    v_exp_f32 v75, v75
    v_mul_f32 v12, v12, v13
    v_add_f32 v12, v12, v60
    v_add_f32 v12, v12, v61
    v_add_f32 v12, v12, v62
    v_add_f32 v12, v12, v63
    v_add_f32 v12, v12, v64
    v_add_f32 v12, v12, v65
    v_add_f32 v12, v12, v66
    v_add_f32 v12, v12, v67
    v_add_f32 v12, v12, v68
    v_add_f32 v12, v12, v69
    v_add_f32 v12, v12, v70
    v_add_f32 v12, v12, v71
    v_add_f32 v12, v12, v72
    v_add_f32 v12, v12, v73
    v_add_f32 v12, v12, v74
    v_add_f32 v12, v12, v75
    v_cvt_pk_bf16_f32 v76, v60, v61
    v_cvt_pk_bf16_f32 v77, v62, v63
    v_cvt_pk_bf16_f32 v78, v64, v65
    v_cvt_pk_bf16_f32 v79, v66, v67
    v_cvt_pk_bf16_f32 v80, v68, v69
    v_cvt_pk_bf16_f32 v81, v70, v71
    v_cvt_pk_bf16_f32 v82, v72, v73
    v_cvt_pk_bf16_f32 v83, v74, v75
    v_mul_f32 v148, v13, v148
    v_mul_f32 v149, v13, v149
    v_mul_f32 v150, v13, v150
    v_mul_f32 v151, v13, v151
    v_mul_f32 v152, v13, v152
    v_mul_f32 v153, v13, v153
    v_mul_f32 v154, v13, v154
    v_mul_f32 v155, v13, v155
    v_mul_f32 v156, v13, v156
    v_mul_f32 v157, v13, v157
    v_mul_f32 v158, v13, v158
    v_mul_f32 v159, v13, v159
    v_mul_f32 v160, v13, v160
    v_mul_f32 v161, v13, v161
    v_mul_f32 v162, v13, v162
    v_mul_f32 v163, v13, v163
    v_mul_f32 v164, v13, v164
    v_mul_f32 v165, v13, v165
    v_mul_f32 v166, v13, v166
    v_mul_f32 v167, v13, v167
    v_mul_f32 v168, v13, v168
    v_mul_f32 v169, v13, v169
    v_mul_f32 v170, v13, v170
    v_mul_f32 v171, v13, v171
    v_mul_f32 v172, v13, v172
    v_mul_f32 v173, v13, v173
    v_mul_f32 v174, v13, v174
    v_mul_f32 v175, v13, v175
    v_mul_f32 v176, v13, v176
    v_mul_f32 v177, v13, v177
    v_mul_f32 v178, v13, v178
    v_mul_f32 v179, v13, v179
    v_mul_f32 v180, v13, v180
    v_mul_f32 v181, v13, v181
    v_mul_f32 v182, v13, v182
    v_mul_f32 v183, v13, v183
    v_mul_f32 v184, v13, v184
    v_mul_f32 v185, v13, v185
    v_mul_f32 v186, v13, v186
    v_mul_f32 v187, v13, v187
    v_mul_f32 v188, v13, v188
    v_mul_f32 v189, v13, v189
    v_mul_f32 v190, v13, v190
    v_mul_f32 v191, v13, v191
    v_mul_f32 v192, v13, v192
    v_mul_f32 v193, v13, v193
    v_mul_f32 v194, v13, v194
    v_mul_f32 v195, v13, v195
    v_mul_f32 v196, v13, v196
    v_mul_f32 v197, v13, v197
    v_mul_f32 v198, v13, v198
    v_mul_f32 v199, v13, v199
    v_mul_f32 v200, v13, v200
    v_mul_f32 v201, v13, v201
    v_mul_f32 v202, v13, v202
    v_mul_f32 v203, v13, v203
    v_mul_f32 v204, v13, v204
    v_mul_f32 v205, v13, v205
    v_mul_f32 v206, v13, v206
    v_mul_f32 v207, v13, v207
    v_mul_f32 v208, v13, v208
    v_mul_f32 v209, v13, v209
    v_mul_f32 v210, v13, v210
    v_mul_f32 v211, v13, v211
    s_waitcnt lgkmcnt(0)
    v_mfma_f32_32x32x16_bf16 v[148:163], v[116:119], v[76:79], v[148:163]
    v_mfma_f32_32x32x16_bf16 v[164:179], v[120:123], v[76:79], v[164:179]
    v_mfma_f32_32x32x16_bf16 v[180:195], v[124:127], v[76:79], v[180:195]
    v_mfma_f32_32x32x16_bf16 v[196:211], v[128:131], v[76:79], v[196:211]
    v_mfma_f32_32x32x16_bf16 v[148:163], v[132:135], v[80:83], v[148:163]
    v_mfma_f32_32x32x16_bf16 v[164:179], v[136:139], v[80:83], v[164:179]
    v_mfma_f32_32x32x16_bf16 v[180:195], v[140:143], v[80:83], v[180:195]
    v_mfma_f32_32x32x16_bf16 v[196:211], v[144:147], v[80:83], v[196:211]
    s_waitcnt vmcnt(8)
    s_barrier
    s_lshl_b32 s30, s3, 11
    s_add_u32 s30, s30, 65536
    s_mov_b32 s31, 98304
    s_mov_b32 m0, s30
    s_add_u32 s30, s30, 1024
    buffer_load_dwordx4 v4, s[8:11], s31 offen lds
    s_mov_b32 m0, s30
    s_add_u32 s30, s30, 15360
    buffer_load_dwordx4 v5, s[8:11], s31 offen lds
    s_mov_b32 m0, s30
    s_nop 0
    buffer_load_dwordx4 v6, s[12:15], s31 offen lds
    buffer_load_dwordx4 v6, s[12:15], s31 offen offset:1024 lds
    ds_read_b128 v[84:87], v16 offset:32768
    ds_read_b128 v[88:91], v17 offset:32768
    ds_read_b128 v[92:95], v18 offset:32768
    ds_read_b128 v[96:99], v19 offset:32768
    ds_read_b128 v[100:103], v20 offset:32768
    ds_read_b128 v[104:107], v21 offset:32768
    ds_read_b128 v[108:111], v22 offset:32768
    ds_read_b128 v[112:115], v23 offset:32768
    s_waitcnt lgkmcnt(7)
    v_mfma_f32_32x32x16_bf16 v[60:75], v[84:87], v[28:31], 0
    s_waitcnt lgkmcnt(6)
    v_mfma_f32_32x32x16_bf16 v[60:75], v[88:91], v[32:35], v[60:75]
    s_waitcnt lgkmcnt(5)
    v_mfma_f32_32x32x16_bf16 v[60:75], v[92:95], v[36:39], v[60:75]
    s_waitcnt lgkmcnt(4)
    v_mfma_f32_32x32x16_bf16 v[60:75], v[96:99], v[40:43], v[60:75]
    s_waitcnt lgkmcnt(3)
    v_mfma_f32_32x32x16_bf16 v[60:75], v[100:103], v[44:47], v[60:75]
    s_waitcnt lgkmcnt(2)
    v_mfma_f32_32x32x16_bf16 v[60:75], v[104:107], v[48:51], v[60:75]
    s_waitcnt lgkmcnt(1)
    v_mfma_f32_32x32x16_bf16 v[60:75], v[108:111], v[52:55], v[60:75]
    s_waitcnt lgkmcnt(0)
    v_mfma_f32_32x32x16_bf16 v[60:75], v[112:115], v[56:59], v[60:75]
    ds_read_b64_tr_b16 v[116:117], v24 offset:49152
    ds_read_b64_tr_b16 v[118:119], v24 offset:51200
    ds_read_b64_tr_b16 v[120:121], v25 offset:49152
    ds_read_b64_tr_b16 v[122:123], v25 offset:51200
    ds_read_b64_tr_b16 v[124:125], v26 offset:49152
    ds_read_b64_tr_b16 v[126:127], v26 offset:51200
    ds_read_b64_tr_b16 v[128:129], v27 offset:49152
    ds_read_b64_tr_b16 v[130:131], v27 offset:51200
    ds_read_b64_tr_b16 v[132:133], v24 offset:53248
    ds_read_b64_tr_b16 v[134:135], v24 offset:55296
    ds_read_b64_tr_b16 v[136:137], v25 offset:53248
    ds_read_b64_tr_b16 v[138:139], v25 offset:55296
    ds_read_b64_tr_b16 v[140:141], v26 offset:53248
    ds_read_b64_tr_b16 v[142:143], v26 offset:55296
    ds_read_b64_tr_b16 v[144:145], v27 offset:53248
    ds_read_b64_tr_b16 v[146:147], v27 offset:55296
    s_nop 7
    s_nop 3
    v_max3_f32 v7, v60, v61, v62
    v_max3_f32 v7, v7, v63, v64
    v_max3_f32 v7, v7, v65, v66
    v_max3_f32 v7, v7, v67, v68
    v_max3_f32 v7, v7, v69, v70
    v_max3_f32 v7, v7, v71, v72
    v_max3_f32 v7, v7, v73, v74
    v_max_f32 v7, v7, v75
    v_mov_b32 v8, v7
    s_nop 1
    v_permlane32_swap_b32 v7, v8
    v_max_f32 v7, v7, v8
    v_mul_f32 v7, s36, v7
    v_max_f32 v7, v7, v11
    v_sub_f32 v13, v11, v7
    v_exp_f32 v13, v13
    v_mov_b32 v11, v7
    v_fma_f32 v60, v60, s36, -v11
    v_exp_f32 v60, v60
    v_fma_f32 v61, v61, s36, -v11
    v_exp_f32 v61, v61
    v_fma_f32 v62, v62, s36, -v11
    v_exp_f32 v62, v62
    v_fma_f32 v63, v63, s36, -v11
    v_exp_f32 v63, v63
    v_fma_f32 v64, v64, s36, -v11
    v_exp_f32 v64, v64
    v_fma_f32 v65, v65, s36, -v11
    v_exp_f32 v65, v65
    v_fma_f32 v66, v66, s36, -v11
    v_exp_f32 v66, v66
    v_fma_f32 v67, v67, s36, -v11
    v_exp_f32 v67, v67
    v_fma_f32 v68, v68, s36, -v11
    v_exp_f32 v68, v68
    v_fma_f32 v69, v69, s36, -v11
    v_exp_f32 v69, v69
    v_fma_f32 v70, v70, s36, -v11
    v_exp_f32 v70, v70
    v_fma_f32 v71, v71, s36, -v11
    v_exp_f32 v71, v71
    v_fma_f32 v72, v72, s36, -v11
    v_exp_f32 v72, v72
    v_fma_f32 v73, v73, s36, -v11
    v_exp_f32 v73, v73
    v_fma_f32 v74, v74, s36, -v11
    v_exp_f32 v74, v74
    v_fma_f32 v75, v75, s36, -v11
    v_exp_f32 v75, v75
    v_mul_f32 v12, v12, v13
    v_add_f32 v12, v12, v60
    v_add_f32 v12, v12, v61
    v_add_f32 v12, v12, v62
    v_add_f32 v12, v12, v63
    v_add_f32 v12, v12, v64
    v_add_f32 v12, v12, v65
    v_add_f32 v12, v12, v66
    v_add_f32 v12, v12, v67
    v_add_f32 v12, v12, v68
    v_add_f32 v12, v12, v69
    v_add_f32 v12, v12, v70
    v_add_f32 v12, v12, v71
    v_add_f32 v12, v12, v72
    v_add_f32 v12, v12, v73
    v_add_f32 v12, v12, v74
    v_add_f32 v12, v12, v75
    v_cvt_pk_bf16_f32 v76, v60, v61
    v_cvt_pk_bf16_f32 v77, v62, v63
    v_cvt_pk_bf16_f32 v78, v64, v65
    v_cvt_pk_bf16_f32 v79, v66, v67
    v_cvt_pk_bf16_f32 v80, v68, v69
    v_cvt_pk_bf16_f32 v81, v70, v71
    v_cvt_pk_bf16_f32 v82, v72, v73
    v_cvt_pk_bf16_f32 v83, v74, v75
    v_mul_f32 v148, v13, v148
    v_mul_f32 v149, v13, v149
    v_mul_f32 v150, v13, v150
    v_mul_f32 v151, v13, v151
    v_mul_f32 v152, v13, v152
    v_mul_f32 v153, v13, v153
    v_mul_f32 v154, v13, v154
    v_mul_f32 v155, v13, v155
    v_mul_f32 v156, v13, v156
    v_mul_f32 v157, v13, v157
    v_mul_f32 v158, v13, v158
    v_mul_f32 v159, v13, v159
    v_mul_f32 v160, v13, v160
    v_mul_f32 v161, v13, v161
    v_mul_f32 v162, v13, v162
    v_mul_f32 v163, v13, v163
    v_mul_f32 v164, v13, v164
    v_mul_f32 v165, v13, v165
    v_mul_f32 v166, v13, v166
    v_mul_f32 v167, v13, v167
    v_mul_f32 v168, v13, v168
    v_mul_f32 v169, v13, v169
    v_mul_f32 v170, v13, v170
    v_mul_f32 v171, v13, v171
    v_mul_f32 v172, v13, v172
    v_mul_f32 v173, v13, v173
    v_mul_f32 v174, v13, v174
    v_mul_f32 v175, v13, v175
    v_mul_f32 v176, v13, v176
    v_mul_f32 v177, v13, v177
    v_mul_f32 v178, v13, v178
    v_mul_f32 v179, v13, v179
    v_mul_f32 v180, v13, v180
    v_mul_f32 v181, v13, v181
    v_mul_f32 v182, v13, v182
    v_mul_f32 v183, v13, v183
    v_mul_f32 v184, v13, v184
    v_mul_f32 v185, v13, v185
    v_mul_f32 v186, v13, v186
    v_mul_f32 v187, v13, v187
    v_mul_f32 v188, v13, v188
    v_mul_f32 v189, v13, v189
    v_mul_f32 v190, v13, v190
    v_mul_f32 v191, v13, v191
    v_mul_f32 v192, v13, v192
    v_mul_f32 v193, v13, v193
    v_mul_f32 v194, v13, v194
    v_mul_f32 v195, v13, v195
    v_mul_f32 v196, v13, v196
    v_mul_f32 v197, v13, v197
    v_mul_f32 v198, v13, v198
    v_mul_f32 v199, v13, v199
    v_mul_f32 v200, v13, v200
    v_mul_f32 v201, v13, v201
    v_mul_f32 v202, v13, v202
    v_mul_f32 v203, v13, v203
    v_mul_f32 v204, v13, v204
    v_mul_f32 v205, v13, v205
    v_mul_f32 v206, v13, v206
    v_mul_f32 v207, v13, v207
    v_mul_f32 v208, v13, v208
    v_mul_f32 v209, v13, v209
    v_mul_f32 v210, v13, v210
    v_mul_f32 v211, v13, v211
    s_waitcnt lgkmcnt(0)
    v_mfma_f32_32x32x16_bf16 v[148:163], v[116:119], v[76:79], v[148:163]
    v_mfma_f32_32x32x16_bf16 v[164:179], v[120:123], v[76:79], v[164:179]
    v_mfma_f32_32x32x16_bf16 v[180:195], v[124:127], v[76:79], v[180:195]
    v_mfma_f32_32x32x16_bf16 v[196:211], v[128:131], v[76:79], v[196:211]
    v_mfma_f32_32x32x16_bf16 v[148:163], v[132:135], v[80:83], v[148:163]
    v_mfma_f32_32x32x16_bf16 v[164:179], v[136:139], v[80:83], v[164:179]
    v_mfma_f32_32x32x16_bf16 v[180:195], v[140:143], v[80:83], v[180:195]
    v_mfma_f32_32x32x16_bf16 v[196:211], v[144:147], v[80:83], v[196:211]
    s_waitcnt vmcnt(8)
    s_barrier
    s_lshl_b32 s30, s3, 11
    s_add_u32 s30, s30, 98304
    s_mov_b32 s31, 114688
    s_mov_b32 m0, s30
    s_add_u32 s30, s30, 1024
    buffer_load_dwordx4 v4, s[8:11], s31 offen lds
    s_mov_b32 m0, s30
    s_add_u32 s30, s30, 15360
    buffer_load_dwordx4 v5, s[8:11], s31 offen lds
    s_mov_b32 m0, s30
    s_nop 0
    buffer_load_dwordx4 v6, s[12:15], s31 offen lds
    buffer_load_dwordx4 v6, s[12:15], s31 offen offset:1024 lds
    v_subrev_u32 v16, 0x10000, v16
    v_subrev_u32 v17, 0x10000, v17
    v_subrev_u32 v18, 0x10000, v18
    v_subrev_u32 v19, 0x10000, v19
    v_subrev_u32 v20, 0x10000, v20
    v_subrev_u32 v21, 0x10000, v21
    v_subrev_u32 v22, 0x10000, v22
    v_subrev_u32 v23, 0x10000, v23
    v_subrev_u32 v24, 0x10000, v24
    v_subrev_u32 v25, 0x10000, v25
    v_subrev_u32 v26, 0x10000, v26
    v_subrev_u32 v27, 0x10000, v27
    ds_read_b128 v[84:87], v16 offset:0
    ds_read_b128 v[88:91], v17 offset:0
    ds_read_b128 v[92:95], v18 offset:0
    ds_read_b128 v[96:99], v19 offset:0
    ds_read_b128 v[100:103], v20 offset:0
    ds_read_b128 v[104:107], v21 offset:0
    ds_read_b128 v[108:111], v22 offset:0
    ds_read_b128 v[112:115], v23 offset:0
    s_waitcnt lgkmcnt(7)
    v_mfma_f32_32x32x16_bf16 v[60:75], v[84:87], v[28:31], 0
    s_waitcnt lgkmcnt(6)
    v_mfma_f32_32x32x16_bf16 v[60:75], v[88:91], v[32:35], v[60:75]
    s_waitcnt lgkmcnt(5)
    v_mfma_f32_32x32x16_bf16 v[60:75], v[92:95], v[36:39], v[60:75]
    s_waitcnt lgkmcnt(4)
    v_mfma_f32_32x32x16_bf16 v[60:75], v[96:99], v[40:43], v[60:75]
    s_waitcnt lgkmcnt(3)
    v_mfma_f32_32x32x16_bf16 v[60:75], v[100:103], v[44:47], v[60:75]
    s_waitcnt lgkmcnt(2)
    v_mfma_f32_32x32x16_bf16 v[60:75], v[104:107], v[48:51], v[60:75]
    s_waitcnt lgkmcnt(1)
    v_mfma_f32_32x32x16_bf16 v[60:75], v[108:111], v[52:55], v[60:75]
    s_waitcnt lgkmcnt(0)
    v_mfma_f32_32x32x16_bf16 v[60:75], v[112:115], v[56:59], v[60:75]
    ds_read_b64_tr_b16 v[116:117], v24 offset:16384
    ds_read_b64_tr_b16 v[118:119], v24 offset:18432
    ds_read_b64_tr_b16 v[120:121], v25 offset:16384
    ds_read_b64_tr_b16 v[122:123], v25 offset:18432
    ds_read_b64_tr_b16 v[124:125], v26 offset:16384
    ds_read_b64_tr_b16 v[126:127], v26 offset:18432
    ds_read_b64_tr_b16 v[128:129], v27 offset:16384
    ds_read_b64_tr_b16 v[130:131], v27 offset:18432
    ds_read_b64_tr_b16 v[132:133], v24 offset:20480
    ds_read_b64_tr_b16 v[134:135], v24 offset:22528
    ds_read_b64_tr_b16 v[136:137], v25 offset:20480
    ds_read_b64_tr_b16 v[138:139], v25 offset:22528
    ds_read_b64_tr_b16 v[140:141], v26 offset:20480
    ds_read_b64_tr_b16 v[142:143], v26 offset:22528
    ds_read_b64_tr_b16 v[144:145], v27 offset:20480
    ds_read_b64_tr_b16 v[146:147], v27 offset:22528
    s_nop 7
    s_nop 3
    v_max3_f32 v7, v60, v61, v62
    v_max3_f32 v7, v7, v63, v64
    v_max3_f32 v7, v7, v65, v66
    v_max3_f32 v7, v7, v67, v68
    v_max3_f32 v7, v7, v69, v70
    v_max3_f32 v7, v7, v71, v72
    v_max3_f32 v7, v7, v73, v74
    v_max_f32 v7, v7, v75
    v_mov_b32 v8, v7
    s_nop 1
    v_permlane32_swap_b32 v7, v8
    v_max_f32 v7, v7, v8
    v_mul_f32 v7, s36, v7
    v_max_f32 v7, v7, v11
    v_sub_f32 v13, v11, v7
    v_exp_f32 v13, v13
    v_mov_b32 v11, v7
    v_fma_f32 v60, v60, s36, -v11
    v_exp_f32 v60, v60
    v_fma_f32 v61, v61, s36, -v11
    v_exp_f32 v61, v61
    v_fma_f32 v62, v62, s36, -v11
    v_exp_f32 v62, v62
    v_fma_f32 v63, v63, s36, -v11
    v_exp_f32 v63, v63
    v_fma_f32 v64, v64, s36, -v11
    v_exp_f32 v64, v64
    v_fma_f32 v65, v65, s36, -v11
    v_exp_f32 v65, v65
    v_fma_f32 v66, v66, s36, -v11
    v_exp_f32 v66, v66
    v_fma_f32 v67, v67, s36, -v11
    v_exp_f32 v67, v67
    v_fma_f32 v68, v68, s36, -v11
    v_exp_f32 v68, v68
    v_fma_f32 v69, v69, s36, -v11
    v_exp_f32 v69, v69
    v_fma_f32 v70, v70, s36, -v11
    v_exp_f32 v70, v70
    v_fma_f32 v71, v71, s36, -v11
    v_exp_f32 v71, v71
    v_fma_f32 v72, v72, s36, -v11
    v_exp_f32 v72, v72
    v_fma_f32 v73, v73, s36, -v11
    v_exp_f32 v73, v73
    v_fma_f32 v74, v74, s36, -v11
    v_exp_f32 v74, v74
    v_fma_f32 v75, v75, s36, -v11
    v_exp_f32 v75, v75
    v_mul_f32 v12, v12, v13
    v_add_f32 v12, v12, v60
    v_add_f32 v12, v12, v61
    v_add_f32 v12, v12, v62
    v_add_f32 v12, v12, v63
    v_add_f32 v12, v12, v64
    v_add_f32 v12, v12, v65
    v_add_f32 v12, v12, v66
    v_add_f32 v12, v12, v67
    v_add_f32 v12, v12, v68
    v_add_f32 v12, v12, v69
    v_add_f32 v12, v12, v70
    v_add_f32 v12, v12, v71
    v_add_f32 v12, v12, v72
    v_add_f32 v12, v12, v73
    v_add_f32 v12, v12, v74
    v_add_f32 v12, v12, v75
    v_cvt_pk_bf16_f32 v76, v60, v61
    v_cvt_pk_bf16_f32 v77, v62, v63
    v_cvt_pk_bf16_f32 v78, v64, v65
    v_cvt_pk_bf16_f32 v79, v66, v67
    v_cvt_pk_bf16_f32 v80, v68, v69
    v_cvt_pk_bf16_f32 v81, v70, v71
    v_cvt_pk_bf16_f32 v82, v72, v73
    v_cvt_pk_bf16_f32 v83, v74, v75
    v_mul_f32 v148, v13, v148
    v_mul_f32 v149, v13, v149
    v_mul_f32 v150, v13, v150
    v_mul_f32 v151, v13, v151
    v_mul_f32 v152, v13, v152
    v_mul_f32 v153, v13, v153
    v_mul_f32 v154, v13, v154
    v_mul_f32 v155, v13, v155
    v_mul_f32 v156, v13, v156
    v_mul_f32 v157, v13, v157
    v_mul_f32 v158, v13, v158
    v_mul_f32 v159, v13, v159
    v_mul_f32 v160, v13, v160
    v_mul_f32 v161, v13, v161
    v_mul_f32 v162, v13, v162
    v_mul_f32 v163, v13, v163
    v_mul_f32 v164, v13, v164
    v_mul_f32 v165, v13, v165
    v_mul_f32 v166, v13, v166
    v_mul_f32 v167, v13, v167
    v_mul_f32 v168, v13, v168
    v_mul_f32 v169, v13, v169
    v_mul_f32 v170, v13, v170
    v_mul_f32 v171, v13, v171
    v_mul_f32 v172, v13, v172
    v_mul_f32 v173, v13, v173
    v_mul_f32 v174, v13, v174
    v_mul_f32 v175, v13, v175
    v_mul_f32 v176, v13, v176
    v_mul_f32 v177, v13, v177
    v_mul_f32 v178, v13, v178
    v_mul_f32 v179, v13, v179
    v_mul_f32 v180, v13, v180
    v_mul_f32 v181, v13, v181
    v_mul_f32 v182, v13, v182
    v_mul_f32 v183, v13, v183
    v_mul_f32 v184, v13, v184
    v_mul_f32 v185, v13, v185
    v_mul_f32 v186, v13, v186
    v_mul_f32 v187, v13, v187
    v_mul_f32 v188, v13, v188
    v_mul_f32 v189, v13, v189
    v_mul_f32 v190, v13, v190
    v_mul_f32 v191, v13, v191
    v_mul_f32 v192, v13, v192
    v_mul_f32 v193, v13, v193
    v_mul_f32 v194, v13, v194
    v_mul_f32 v195, v13, v195
    v_mul_f32 v196, v13, v196
    v_mul_f32 v197, v13, v197
    v_mul_f32 v198, v13, v198
    v_mul_f32 v199, v13, v199
    v_mul_f32 v200, v13, v200
    v_mul_f32 v201, v13, v201
    v_mul_f32 v202, v13, v202
    v_mul_f32 v203, v13, v203
    v_mul_f32 v204, v13, v204
    v_mul_f32 v205, v13, v205
    v_mul_f32 v206, v13, v206
    v_mul_f32 v207, v13, v207
    v_mul_f32 v208, v13, v208
    v_mul_f32 v209, v13, v209
    v_mul_f32 v210, v13, v210
    v_mul_f32 v211, v13, v211
    s_waitcnt lgkmcnt(0)
    v_mfma_f32_32x32x16_bf16 v[148:163], v[116:119], v[76:79], v[148:163]
    v_mfma_f32_32x32x16_bf16 v[164:179], v[120:123], v[76:79], v[164:179]
    v_mfma_f32_32x32x16_bf16 v[180:195], v[124:127], v[76:79], v[180:195]
    v_mfma_f32_32x32x16_bf16 v[196:211], v[128:131], v[76:79], v[196:211]
    v_mfma_f32_32x32x16_bf16 v[148:163], v[132:135], v[80:83], v[148:163]
    v_mfma_f32_32x32x16_bf16 v[164:179], v[136:139], v[80:83], v[164:179]
    v_mfma_f32_32x32x16_bf16 v[180:195], v[140:143], v[80:83], v[180:195]
    v_mfma_f32_32x32x16_bf16 v[196:211], v[144:147], v[80:83], v[196:211]
    s_waitcnt vmcnt(8)
    s_barrier
    s_lshl_b32 s30, s3, 11
    s_add_u32 s30, s30, 0
    s_mov_b32 s31, 131072
    s_mov_b32 m0, s30
    s_add_u32 s30, s30, 1024
    buffer_load_dwordx4 v4, s[8:11], s31 offen lds
    s_mov_b32 m0, s30
    s_add_u32 s30, s30, 15360
    buffer_load_dwordx4 v5, s[8:11], s31 offen lds
    s_mov_b32 m0, s30
    s_nop 0
    buffer_load_dwordx4 v6, s[12:15], s31 offen lds
    buffer_load_dwordx4 v6, s[12:15], s31 offen offset:1024 lds
    ds_read_b128 v[84:87], v16 offset:32768
    ds_read_b128 v[88:91], v17 offset:32768
    ds_read_b128 v[92:95], v18 offset:32768
    ds_read_b128 v[96:99], v19 offset:32768
    ds_read_b128 v[100:103], v20 offset:32768
    ds_read_b128 v[104:107], v21 offset:32768
    ds_read_b128 v[108:111], v22 offset:32768
    ds_read_b128 v[112:115], v23 offset:32768
    s_waitcnt lgkmcnt(7)
    v_mfma_f32_32x32x16_bf16 v[60:75], v[84:87], v[28:31], 0
    s_waitcnt lgkmcnt(6)
    v_mfma_f32_32x32x16_bf16 v[60:75], v[88:91], v[32:35], v[60:75]
    s_waitcnt lgkmcnt(5)
    v_mfma_f32_32x32x16_bf16 v[60:75], v[92:95], v[36:39], v[60:75]
    s_waitcnt lgkmcnt(4)
    v_mfma_f32_32x32x16_bf16 v[60:75], v[96:99], v[40:43], v[60:75]
    s_waitcnt lgkmcnt(3)
    v_mfma_f32_32x32x16_bf16 v[60:75], v[100:103], v[44:47], v[60:75]
    s_waitcnt lgkmcnt(2)
    v_mfma_f32_32x32x16_bf16 v[60:75], v[104:107], v[48:51], v[60:75]
    s_waitcnt lgkmcnt(1)
    v_mfma_f32_32x32x16_bf16 v[60:75], v[108:111], v[52:55], v[60:75]
    s_waitcnt lgkmcnt(0)
    v_mfma_f32_32x32x16_bf16 v[60:75], v[112:115], v[56:59], v[60:75]
    ds_read_b64_tr_b16 v[116:117], v24 offset:49152
    ds_read_b64_tr_b16 v[118:119], v24 offset:51200
    ds_read_b64_tr_b16 v[120:121], v25 offset:49152
    ds_read_b64_tr_b16 v[122:123], v25 offset:51200
    ds_read_b64_tr_b16 v[124:125], v26 offset:49152
    ds_read_b64_tr_b16 v[126:127], v26 offset:51200
    ds_read_b64_tr_b16 v[128:129], v27 offset:49152
    ds_read_b64_tr_b16 v[130:131], v27 offset:51200
    ds_read_b64_tr_b16 v[132:133], v24 offset:53248
    ds_read_b64_tr_b16 v[134:135], v24 offset:55296
    ds_read_b64_tr_b16 v[136:137], v25 offset:53248
    ds_read_b64_tr_b16 v[138:139], v25 offset:55296
    ds_read_b64_tr_b16 v[140:141], v26 offset:53248
    ds_read_b64_tr_b16 v[142:143], v26 offset:55296
    ds_read_b64_tr_b16 v[144:145], v27 offset:53248
    ds_read_b64_tr_b16 v[146:147], v27 offset:55296
    s_nop 7
    s_nop 3
    v_max3_f32 v7, v60, v61, v62
    v_max3_f32 v7, v7, v63, v64
    v_max3_f32 v7, v7, v65, v66
    v_max3_f32 v7, v7, v67, v68
    v_max3_f32 v7, v7, v69, v70
    v_max3_f32 v7, v7, v71, v72
    v_max3_f32 v7, v7, v73, v74
    v_max_f32 v7, v7, v75
    v_mov_b32 v8, v7
    s_nop 1
    v_permlane32_swap_b32 v7, v8
    v_max_f32 v7, v7, v8
    v_mul_f32 v7, s36, v7
    v_max_f32 v7, v7, v11
    v_sub_f32 v13, v11, v7
    v_exp_f32 v13, v13
    v_mov_b32 v11, v7
    v_fma_f32 v60, v60, s36, -v11
    v_exp_f32 v60, v60
    v_fma_f32 v61, v61, s36, -v11
    v_exp_f32 v61, v61
    v_fma_f32 v62, v62, s36, -v11
    v_exp_f32 v62, v62
    v_fma_f32 v63, v63, s36, -v11
    v_exp_f32 v63, v63
    v_fma_f32 v64, v64, s36, -v11
    v_exp_f32 v64, v64
    v_fma_f32 v65, v65, s36, -v11
    v_exp_f32 v65, v65
    v_fma_f32 v66, v66, s36, -v11
    v_exp_f32 v66, v66
    v_fma_f32 v67, v67, s36, -v11
    v_exp_f32 v67, v67
    v_fma_f32 v68, v68, s36, -v11
    v_exp_f32 v68, v68
    v_fma_f32 v69, v69, s36, -v11
    v_exp_f32 v69, v69
    v_fma_f32 v70, v70, s36, -v11
    v_exp_f32 v70, v70
    v_fma_f32 v71, v71, s36, -v11
    v_exp_f32 v71, v71
    v_fma_f32 v72, v72, s36, -v11
    v_exp_f32 v72, v72
    v_fma_f32 v73, v73, s36, -v11
    v_exp_f32 v73, v73
    v_fma_f32 v74, v74, s36, -v11
    v_exp_f32 v74, v74
    v_fma_f32 v75, v75, s36, -v11
    v_exp_f32 v75, v75
    v_mul_f32 v12, v12, v13
    v_add_f32 v12, v12, v60
    v_add_f32 v12, v12, v61
    v_add_f32 v12, v12, v62
    v_add_f32 v12, v12, v63
    v_add_f32 v12, v12, v64
    v_add_f32 v12, v12, v65
    v_add_f32 v12, v12, v66
    v_add_f32 v12, v12, v67
    v_add_f32 v12, v12, v68
    v_add_f32 v12, v12, v69
    v_add_f32 v12, v12, v70
    v_add_f32 v12, v12, v71
    v_add_f32 v12, v12, v72
    v_add_f32 v12, v12, v73
    v_add_f32 v12, v12, v74
    v_add_f32 v12, v12, v75
    v_cvt_pk_bf16_f32 v76, v60, v61
    v_cvt_pk_bf16_f32 v77, v62, v63
    v_cvt_pk_bf16_f32 v78, v64, v65
    v_cvt_pk_bf16_f32 v79, v66, v67
    v_cvt_pk_bf16_f32 v80, v68, v69
    v_cvt_pk_bf16_f32 v81, v70, v71
    v_cvt_pk_bf16_f32 v82, v72, v73
    v_cvt_pk_bf16_f32 v83, v74, v75
    v_mul_f32 v148, v13, v148
    v_mul_f32 v149, v13, v149
    v_mul_f32 v150, v13, v150
    v_mul_f32 v151, v13, v151
    v_mul_f32 v152, v13, v152
    v_mul_f32 v153, v13, v153
    v_mul_f32 v154, v13, v154
    v_mul_f32 v155, v13, v155
    v_mul_f32 v156, v13, v156
    v_mul_f32 v157, v13, v157
    v_mul_f32 v158, v13, v158
    v_mul_f32 v159, v13, v159
    v_mul_f32 v160, v13, v160
    v_mul_f32 v161, v13, v161
    v_mul_f32 v162, v13, v162
    v_mul_f32 v163, v13, v163
    v_mul_f32 v164, v13, v164
    v_mul_f32 v165, v13, v165
    v_mul_f32 v166, v13, v166
    v_mul_f32 v167, v13, v167
    v_mul_f32 v168, v13, v168
    v_mul_f32 v169, v13, v169
    v_mul_f32 v170, v13, v170
    v_mul_f32 v171, v13, v171
    v_mul_f32 v172, v13, v172
    v_mul_f32 v173, v13, v173
    v_mul_f32 v174, v13, v174
    v_mul_f32 v175, v13, v175
    v_mul_f32 v176, v13, v176
    v_mul_f32 v177, v13, v177
    v_mul_f32 v178, v13, v178
    v_mul_f32 v179, v13, v179
    v_mul_f32 v180, v13, v180
    v_mul_f32 v181, v13, v181
    v_mul_f32 v182, v13, v182
    v_mul_f32 v183, v13, v183
    v_mul_f32 v184, v13, v184
    v_mul_f32 v185, v13, v185
    v_mul_f32 v186, v13, v186
    v_mul_f32 v187, v13, v187
    v_mul_f32 v188, v13, v188
    v_mul_f32 v189, v13, v189
    v_mul_f32 v190, v13, v190
    v_mul_f32 v191, v13, v191
    v_mul_f32 v192, v13, v192
    v_mul_f32 v193, v13, v193
    v_mul_f32 v194, v13, v194
    v_mul_f32 v195, v13, v195
    v_mul_f32 v196, v13, v196
    v_mul_f32 v197, v13, v197
    v_mul_f32 v198, v13, v198
    v_mul_f32 v199, v13, v199
    v_mul_f32 v200, v13, v200
    v_mul_f32 v201, v13, v201
    v_mul_f32 v202, v13, v202
    v_mul_f32 v203, v13, v203
    v_mul_f32 v204, v13, v204
    v_mul_f32 v205, v13, v205
    v_mul_f32 v206, v13, v206
    v_mul_f32 v207, v13, v207
    v_mul_f32 v208, v13, v208
    v_mul_f32 v209, v13, v209
    v_mul_f32 v210, v13, v210
    v_mul_f32 v211, v13, v211
    s_waitcnt lgkmcnt(0)
    v_mfma_f32_32x32x16_bf16 v[148:163], v[116:119], v[76:79], v[148:163]
    v_mfma_f32_32x32x16_bf16 v[164:179], v[120:123], v[76:79], v[164:179]
    v_mfma_f32_32x32x16_bf16 v[180:195], v[124:127], v[76:79], v[180:195]
    v_mfma_f32_32x32x16_bf16 v[196:211], v[128:131], v[76:79], v[196:211]
    v_mfma_f32_32x32x16_bf16 v[148:163], v[132:135], v[80:83], v[148:163]
    v_mfma_f32_32x32x16_bf16 v[164:179], v[136:139], v[80:83], v[164:179]
    v_mfma_f32_32x32x16_bf16 v[180:195], v[140:143], v[80:83], v[180:195]
    v_mfma_f32_32x32x16_bf16 v[196:211], v[144:147], v[80:83], v[196:211]
    s_waitcnt vmcnt(8)
    s_barrier
    s_lshl_b32 s30, s3, 11
    s_add_u32 s30, s30, 32768
    s_mov_b32 s31, 147456
    s_mov_b32 m0, s30
    s_add_u32 s30, s30, 1024
    buffer_load_dwordx4 v4, s[8:11], s31 offen lds
    s_mov_b32 m0, s30
    s_add_u32 s30, s30, 15360
    buffer_load_dwordx4 v5, s[8:11], s31 offen lds
    s_mov_b32 m0, s30
    s_nop 0
    buffer_load_dwordx4 v6, s[12:15], s31 offen lds
    buffer_load_dwordx4 v6, s[12:15], s31 offen offset:1024 lds
    v_add_u32 v16, 0x10000, v16
    v_add_u32 v17, 0x10000, v17
    v_add_u32 v18, 0x10000, v18
    v_add_u32 v19, 0x10000, v19
    v_add_u32 v20, 0x10000, v20
    v_add_u32 v21, 0x10000, v21
    v_add_u32 v22, 0x10000, v22
    v_add_u32 v23, 0x10000, v23
    v_add_u32 v24, 0x10000, v24
    v_add_u32 v25, 0x10000, v25
    v_add_u32 v26, 0x10000, v26
    v_add_u32 v27, 0x10000, v27
    ds_read_b128 v[84:87], v16 offset:0
    ds_read_b128 v[88:91], v17 offset:0
    ds_read_b128 v[92:95], v18 offset:0
    ds_read_b128 v[96:99], v19 offset:0
    ds_read_b128 v[100:103], v20 offset:0
    ds_read_b128 v[104:107], v21 offset:0
    ds_read_b128 v[108:111], v22 offset:0
    ds_read_b128 v[112:115], v23 offset:0
    s_waitcnt lgkmcnt(7)
    v_mfma_f32_32x32x16_bf16 v[60:75], v[84:87], v[28:31], 0
    s_waitcnt lgkmcnt(6)
    v_mfma_f32_32x32x16_bf16 v[60:75], v[88:91], v[32:35], v[60:75]
    s_waitcnt lgkmcnt(5)
    v_mfma_f32_32x32x16_bf16 v[60:75], v[92:95], v[36:39], v[60:75]
    s_waitcnt lgkmcnt(4)
    v_mfma_f32_32x32x16_bf16 v[60:75], v[96:99], v[40:43], v[60:75]
    s_waitcnt lgkmcnt(3)
    v_mfma_f32_32x32x16_bf16 v[60:75], v[100:103], v[44:47], v[60:75]
    s_waitcnt lgkmcnt(2)
    v_mfma_f32_32x32x16_bf16 v[60:75], v[104:107], v[48:51], v[60:75]
    s_waitcnt lgkmcnt(1)
    v_mfma_f32_32x32x16_bf16 v[60:75], v[108:111], v[52:55], v[60:75]
    s_waitcnt lgkmcnt(0)
    v_mfma_f32_32x32x16_bf16 v[60:75], v[112:115], v[56:59], v[60:75]
    ds_read_b64_tr_b16 v[116:117], v24 offset:16384
    ds_read_b64_tr_b16 v[118:119], v24 offset:18432
    ds_read_b64_tr_b16 v[120:121], v25 offset:16384
    ds_read_b64_tr_b16 v[122:123], v25 offset:18432
    ds_read_b64_tr_b16 v[124:125], v26 offset:16384
    ds_read_b64_tr_b16 v[126:127], v26 offset:18432
    ds_read_b64_tr_b16 v[128:129], v27 offset:16384
    ds_read_b64_tr_b16 v[130:131], v27 offset:18432
    ds_read_b64_tr_b16 v[132:133], v24 offset:20480
    ds_read_b64_tr_b16 v[134:135], v24 offset:22528
    ds_read_b64_tr_b16 v[136:137], v25 offset:20480
    ds_read_b64_tr_b16 v[138:139], v25 offset:22528
    ds_read_b64_tr_b16 v[140:141], v26 offset:20480
    ds_read_b64_tr_b16 v[142:143], v26 offset:22528
    ds_read_b64_tr_b16 v[144:145], v27 offset:20480
    ds_read_b64_tr_b16 v[146:147], v27 offset:22528
    s_nop 7
    s_nop 3
    v_max3_f32 v7, v60, v61, v62
    v_max3_f32 v7, v7, v63, v64
    v_max3_f32 v7, v7, v65, v66
    v_max3_f32 v7, v7, v67, v68
    v_max3_f32 v7, v7, v69, v70
    v_max3_f32 v7, v7, v71, v72
    v_max3_f32 v7, v7, v73, v74
    v_max_f32 v7, v7, v75
    v_mov_b32 v8, v7
    s_nop 1
    v_permlane32_swap_b32 v7, v8
    v_max_f32 v7, v7, v8
    v_mul_f32 v7, s36, v7
    v_max_f32 v7, v7, v11
    v_sub_f32 v13, v11, v7
    v_exp_f32 v13, v13
    v_mov_b32 v11, v7
    v_fma_f32 v60, v60, s36, -v11
    v_exp_f32 v60, v60
    v_fma_f32 v61, v61, s36, -v11
    v_exp_f32 v61, v61
    v_fma_f32 v62, v62, s36, -v11
    v_exp_f32 v62, v62
    v_fma_f32 v63, v63, s36, -v11
    v_exp_f32 v63, v63
    v_fma_f32 v64, v64, s36, -v11
    v_exp_f32 v64, v64
    v_fma_f32 v65, v65, s36, -v11
    v_exp_f32 v65, v65
    v_fma_f32 v66, v66, s36, -v11
    v_exp_f32 v66, v66
    v_fma_f32 v67, v67, s36, -v11
    v_exp_f32 v67, v67
    v_fma_f32 v68, v68, s36, -v11
    v_exp_f32 v68, v68
    v_fma_f32 v69, v69, s36, -v11
    v_exp_f32 v69, v69
    v_fma_f32 v70, v70, s36, -v11
    v_exp_f32 v70, v70
    v_fma_f32 v71, v71, s36, -v11
    v_exp_f32 v71, v71
    v_fma_f32 v72, v72, s36, -v11
    v_exp_f32 v72, v72
    v_fma_f32 v73, v73, s36, -v11
    v_exp_f32 v73, v73
    v_fma_f32 v74, v74, s36, -v11
    v_exp_f32 v74, v74
    v_fma_f32 v75, v75, s36, -v11
    v_exp_f32 v75, v75
    v_mul_f32 v12, v12, v13
    v_add_f32 v12, v12, v60
    v_add_f32 v12, v12, v61
    v_add_f32 v12, v12, v62
    v_add_f32 v12, v12, v63
    v_add_f32 v12, v12, v64
    v_add_f32 v12, v12, v65
    v_add_f32 v12, v12, v66
    v_add_f32 v12, v12, v67
    v_add_f32 v12, v12, v68
    v_add_f32 v12, v12, v69
    v_add_f32 v12, v12, v70
    v_add_f32 v12, v12, v71
    v_add_f32 v12, v12, v72
    v_add_f32 v12, v12, v73
    v_add_f32 v12, v12, v74
    v_add_f32 v12, v12, v75
    v_cvt_pk_bf16_f32 v76, v60, v61
    v_cvt_pk_bf16_f32 v77, v62, v63
    v_cvt_pk_bf16_f32 v78, v64, v65
    v_cvt_pk_bf16_f32 v79, v66, v67
    v_cvt_pk_bf16_f32 v80, v68, v69
    v_cvt_pk_bf16_f32 v81, v70, v71
    v_cvt_pk_bf16_f32 v82, v72, v73
    v_cvt_pk_bf16_f32 v83, v74, v75
    v_mul_f32 v148, v13, v148
    v_mul_f32 v149, v13, v149
    v_mul_f32 v150, v13, v150
    v_mul_f32 v151, v13, v151
    v_mul_f32 v152, v13, v152
    v_mul_f32 v153, v13, v153
    v_mul_f32 v154, v13, v154
    v_mul_f32 v155, v13, v155
    v_mul_f32 v156, v13, v156
    v_mul_f32 v157, v13, v157
    v_mul_f32 v158, v13, v158
    v_mul_f32 v159, v13, v159
    v_mul_f32 v160, v13, v160
    v_mul_f32 v161, v13, v161
    v_mul_f32 v162, v13, v162
    v_mul_f32 v163, v13, v163
    v_mul_f32 v164, v13, v164
    v_mul_f32 v165, v13, v165
    v_mul_f32 v166, v13, v166
    v_mul_f32 v167, v13, v167
    v_mul_f32 v168, v13, v168
    v_mul_f32 v169, v13, v169
    v_mul_f32 v170, v13, v170
    v_mul_f32 v171, v13, v171
    v_mul_f32 v172, v13, v172
    v_mul_f32 v173, v13, v173
    v_mul_f32 v174, v13, v174
    v_mul_f32 v175, v13, v175
    v_mul_f32 v176, v13, v176
    v_mul_f32 v177, v13, v177
    v_mul_f32 v178, v13, v178
    v_mul_f32 v179, v13, v179
    v_mul_f32 v180, v13, v180
    v_mul_f32 v181, v13, v181
    v_mul_f32 v182, v13, v182
    v_mul_f32 v183, v13, v183
    v_mul_f32 v184, v13, v184
    v_mul_f32 v185, v13, v185
    v_mul_f32 v186, v13, v186
    v_mul_f32 v187, v13, v187
    v_mul_f32 v188, v13, v188
    v_mul_f32 v189, v13, v189
    v_mul_f32 v190, v13, v190
    v_mul_f32 v191, v13, v191
    v_mul_f32 v192, v13, v192
    v_mul_f32 v193, v13, v193
    v_mul_f32 v194, v13, v194
    v_mul_f32 v195, v13, v195
    v_mul_f32 v196, v13, v196
    v_mul_f32 v197, v13, v197
    v_mul_f32 v198, v13, v198
    v_mul_f32 v199, v13, v199
    v_mul_f32 v200, v13, v200
    v_mul_f32 v201, v13, v201
    v_mul_f32 v202, v13, v202
    v_mul_f32 v203, v13, v203
    v_mul_f32 v204, v13, v204
    v_mul_f32 v205, v13, v205
    v_mul_f32 v206, v13, v206
    v_mul_f32 v207, v13, v207
    v_mul_f32 v208, v13, v208
    v_mul_f32 v209, v13, v209
    v_mul_f32 v210, v13, v210
    v_mul_f32 v211, v13, v211
    s_waitcnt lgkmcnt(0)
    v_mfma_f32_32x32x16_bf16 v[148:163], v[116:119], v[76:79], v[148:163]
    v_mfma_f32_32x32x16_bf16 v[164:179], v[120:123], v[76:79], v[164:179]
    v_mfma_f32_32x32x16_bf16 v[180:195], v[124:127], v[76:79], v[180:195]
    v_mfma_f32_32x32x16_bf16 v[196:211], v[128:131], v[76:79], v[196:211]
    v_mfma_f32_32x32x16_bf16 v[148:163], v[132:135], v[80:83], v[148:163]
    v_mfma_f32_32x32x16_bf16 v[164:179], v[136:139], v[80:83], v[164:179]
    v_mfma_f32_32x32x16_bf16 v[180:195], v[140:143], v[80:83], v[180:195]
    v_mfma_f32_32x32x16_bf16 v[196:211], v[144:147], v[80:83], v[196:211]
    s_waitcnt vmcnt(8)
    s_barrier
    s_lshl_b32 s30, s3, 11
    s_add_u32 s30, s30, 65536
    s_mov_b32 s31, 163840
    s_mov_b32 m0, s30
    s_add_u32 s30, s30, 1024
    buffer_load_dwordx4 v4, s[8:11], s31 offen lds
    s_mov_b32 m0, s30
    s_add_u32 s30, s30, 15360
    buffer_load_dwordx4 v5, s[8:11], s31 offen lds
    s_mov_b32 m0, s30
    s_nop 0
    buffer_load_dwordx4 v6, s[12:15], s31 offen lds
    buffer_load_dwordx4 v6, s[12:15], s31 offen offset:1024 lds
    ds_read_b128 v[84:87], v16 offset:32768
    ds_read_b128 v[88:91], v17 offset:32768
    ds_read_b128 v[92:95], v18 offset:32768
    ds_read_b128 v[96:99], v19 offset:32768
    ds_read_b128 v[100:103], v20 offset:32768
    ds_read_b128 v[104:107], v21 offset:32768
    ds_read_b128 v[108:111], v22 offset:32768
    ds_read_b128 v[112:115], v23 offset:32768
    s_waitcnt lgkmcnt(7)
    v_mfma_f32_32x32x16_bf16 v[60:75], v[84:87], v[28:31], 0
    s_waitcnt lgkmcnt(6)
    v_mfma_f32_32x32x16_bf16 v[60:75], v[88:91], v[32:35], v[60:75]
    s_waitcnt lgkmcnt(5)
    v_mfma_f32_32x32x16_bf16 v[60:75], v[92:95], v[36:39], v[60:75]
    s_waitcnt lgkmcnt(4)
    v_mfma_f32_32x32x16_bf16 v[60:75], v[96:99], v[40:43], v[60:75]
    s_waitcnt lgkmcnt(3)
    v_mfma_f32_32x32x16_bf16 v[60:75], v[100:103], v[44:47], v[60:75]
    s_waitcnt lgkmcnt(2)
    v_mfma_f32_32x32x16_bf16 v[60:75], v[104:107], v[48:51], v[60:75]
    s_waitcnt lgkmcnt(1)
    v_mfma_f32_32x32x16_bf16 v[60:75], v[108:111], v[52:55], v[60:75]
    s_waitcnt lgkmcnt(0)
    v_mfma_f32_32x32x16_bf16 v[60:75], v[112:115], v[56:59], v[60:75]
    ds_read_b64_tr_b16 v[116:117], v24 offset:49152
    ds_read_b64_tr_b16 v[118:119], v24 offset:51200
    ds_read_b64_tr_b16 v[120:121], v25 offset:49152
    ds_read_b64_tr_b16 v[122:123], v25 offset:51200
    ds_read_b64_tr_b16 v[124:125], v26 offset:49152
    ds_read_b64_tr_b16 v[126:127], v26 offset:51200
    ds_read_b64_tr_b16 v[128:129], v27 offset:49152
    ds_read_b64_tr_b16 v[130:131], v27 offset:51200
    ds_read_b64_tr_b16 v[132:133], v24 offset:53248
    ds_read_b64_tr_b16 v[134:135], v24 offset:55296
    ds_read_b64_tr_b16 v[136:137], v25 offset:53248
    ds_read_b64_tr_b16 v[138:139], v25 offset:55296
    ds_read_b64_tr_b16 v[140:141], v26 offset:53248
    ds_read_b64_tr_b16 v[142:143], v26 offset:55296
    ds_read_b64_tr_b16 v[144:145], v27 offset:53248
    ds_read_b64_tr_b16 v[146:147], v27 offset:55296
    s_nop 7
    s_nop 3
    v_max3_f32 v7, v60, v61, v62
    v_max3_f32 v7, v7, v63, v64
    v_max3_f32 v7, v7, v65, v66
    v_max3_f32 v7, v7, v67, v68
    v_max3_f32 v7, v7, v69, v70
    v_max3_f32 v7, v7, v71, v72
    v_max3_f32 v7, v7, v73, v74
    v_max_f32 v7, v7, v75
    v_mov_b32 v8, v7
    s_nop 1
    v_permlane32_swap_b32 v7, v8
    v_max_f32 v7, v7, v8
    v_mul_f32 v7, s36, v7
    v_max_f32 v7, v7, v11
    v_sub_f32 v13, v11, v7
    v_exp_f32 v13, v13
    v_mov_b32 v11, v7
    v_fma_f32 v60, v60, s36, -v11
    v_exp_f32 v60, v60
    v_fma_f32 v61, v61, s36, -v11
    v_exp_f32 v61, v61
    v_fma_f32 v62, v62, s36, -v11
    v_exp_f32 v62, v62
    v_fma_f32 v63, v63, s36, -v11
    v_exp_f32 v63, v63
    v_fma_f32 v64, v64, s36, -v11
    v_exp_f32 v64, v64
    v_fma_f32 v65, v65, s36, -v11
    v_exp_f32 v65, v65
    v_fma_f32 v66, v66, s36, -v11
    v_exp_f32 v66, v66
    v_fma_f32 v67, v67, s36, -v11
    v_exp_f32 v67, v67
    v_fma_f32 v68, v68, s36, -v11
    v_exp_f32 v68, v68
    v_fma_f32 v69, v69, s36, -v11
    v_exp_f32 v69, v69
    v_fma_f32 v70, v70, s36, -v11
    v_exp_f32 v70, v70
    v_fma_f32 v71, v71, s36, -v11
    v_exp_f32 v71, v71
    v_fma_f32 v72, v72, s36, -v11
    v_exp_f32 v72, v72
    v_fma_f32 v73, v73, s36, -v11
    v_exp_f32 v73, v73
    v_fma_f32 v74, v74, s36, -v11
    v_exp_f32 v74, v74
    v_fma_f32 v75, v75, s36, -v11
    v_exp_f32 v75, v75
    v_mul_f32 v12, v12, v13
    v_add_f32 v12, v12, v60
    v_add_f32 v12, v12, v61
    v_add_f32 v12, v12, v62
    v_add_f32 v12, v12, v63
    v_add_f32 v12, v12, v64
    v_add_f32 v12, v12, v65
    v_add_f32 v12, v12, v66
    v_add_f32 v12, v12, v67
    v_add_f32 v12, v12, v68
    v_add_f32 v12, v12, v69
    v_add_f32 v12, v12, v70
    v_add_f32 v12, v12, v71
    v_add_f32 v12, v12, v72
    v_add_f32 v12, v12, v73
    v_add_f32 v12, v12, v74
    v_add_f32 v12, v12, v75
    v_cvt_pk_bf16_f32 v76, v60, v61
    v_cvt_pk_bf16_f32 v77, v62, v63
    v_cvt_pk_bf16_f32 v78, v64, v65
    v_cvt_pk_bf16_f32 v79, v66, v67
    v_cvt_pk_bf16_f32 v80, v68, v69
    v_cvt_pk_bf16_f32 v81, v70, v71
    v_cvt_pk_bf16_f32 v82, v72, v73
    v_cvt_pk_bf16_f32 v83, v74, v75
    v_mul_f32 v148, v13, v148
    v_mul_f32 v149, v13, v149
    v_mul_f32 v150, v13, v150
    v_mul_f32 v151, v13, v151
    v_mul_f32 v152, v13, v152
    v_mul_f32 v153, v13, v153
    v_mul_f32 v154, v13, v154
    v_mul_f32 v155, v13, v155
    v_mul_f32 v156, v13, v156
    v_mul_f32 v157, v13, v157
    v_mul_f32 v158, v13, v158
    v_mul_f32 v159, v13, v159
    v_mul_f32 v160, v13, v160
    v_mul_f32 v161, v13, v161
    v_mul_f32 v162, v13, v162
    v_mul_f32 v163, v13, v163
    v_mul_f32 v164, v13, v164
    v_mul_f32 v165, v13, v165
    v_mul_f32 v166, v13, v166
    v_mul_f32 v167, v13, v167
    v_mul_f32 v168, v13, v168
    v_mul_f32 v169, v13, v169
    v_mul_f32 v170, v13, v170
    v_mul_f32 v171, v13, v171
    v_mul_f32 v172, v13, v172
    v_mul_f32 v173, v13, v173
    v_mul_f32 v174, v13, v174
    v_mul_f32 v175, v13, v175
    v_mul_f32 v176, v13, v176
    v_mul_f32 v177, v13, v177
    v_mul_f32 v178, v13, v178
    v_mul_f32 v179, v13, v179
    v_mul_f32 v180, v13, v180
    v_mul_f32 v181, v13, v181
    v_mul_f32 v182, v13, v182
    v_mul_f32 v183, v13, v183
    v_mul_f32 v184, v13, v184
    v_mul_f32 v185, v13, v185
    v_mul_f32 v186, v13, v186
    v_mul_f32 v187, v13, v187
    v_mul_f32 v188, v13, v188
    v_mul_f32 v189, v13, v189
    v_mul_f32 v190, v13, v190
    v_mul_f32 v191, v13, v191
    v_mul_f32 v192, v13, v192
    v_mul_f32 v193, v13, v193
    v_mul_f32 v194, v13, v194
    v_mul_f32 v195, v13, v195
    v_mul_f32 v196, v13, v196
    v_mul_f32 v197, v13, v197
    v_mul_f32 v198, v13, v198
    v_mul_f32 v199, v13, v199
    v_mul_f32 v200, v13, v200
    v_mul_f32 v201, v13, v201
    v_mul_f32 v202, v13, v202
    v_mul_f32 v203, v13, v203
    v_mul_f32 v204, v13, v204
    v_mul_f32 v205, v13, v205
    v_mul_f32 v206, v13, v206
    v_mul_f32 v207, v13, v207
    v_mul_f32 v208, v13, v208
    v_mul_f32 v209, v13, v209
    v_mul_f32 v210, v13, v210
    v_mul_f32 v211, v13, v211
    s_waitcnt lgkmcnt(0)
    v_mfma_f32_32x32x16_bf16 v[148:163], v[116:119], v[76:79], v[148:163]
    v_mfma_f32_32x32x16_bf16 v[164:179], v[120:123], v[76:79], v[164:179]
    v_mfma_f32_32x32x16_bf16 v[180:195], v[124:127], v[76:79], v[180:195]
    v_mfma_f32_32x32x16_bf16 v[196:211], v[128:131], v[76:79], v[196:211]
    v_mfma_f32_32x32x16_bf16 v[148:163], v[132:135], v[80:83], v[148:163]
    v_mfma_f32_32x32x16_bf16 v[164:179], v[136:139], v[80:83], v[164:179]
    v_mfma_f32_32x32x16_bf16 v[180:195], v[140:143], v[80:83], v[180:195]
    v_mfma_f32_32x32x16_bf16 v[196:211], v[144:147], v[80:83], v[196:211]
    s_waitcnt vmcnt(8)
    s_barrier
    s_lshl_b32 s30, s3, 11
    s_add_u32 s30, s30, 98304
    s_mov_b32 s31, 180224
    s_mov_b32 m0, s30
    s_add_u32 s30, s30, 1024
    buffer_load_dwordx4 v4, s[8:11], s31 offen lds
    s_mov_b32 m0, s30
    s_add_u32 s30, s30, 15360
    buffer_load_dwordx4 v5, s[8:11], s31 offen lds
    s_mov_b32 m0, s30
    s_nop 0
    buffer_load_dwordx4 v6, s[12:15], s31 offen lds
    buffer_load_dwordx4 v6, s[12:15], s31 offen offset:1024 lds
    v_subrev_u32 v16, 0x10000, v16
    v_subrev_u32 v17, 0x10000, v17
    v_subrev_u32 v18, 0x10000, v18
    v_subrev_u32 v19, 0x10000, v19
    v_subrev_u32 v20, 0x10000, v20
    v_subrev_u32 v21, 0x10000, v21
    v_subrev_u32 v22, 0x10000, v22
    v_subrev_u32 v23, 0x10000, v23
    v_subrev_u32 v24, 0x10000, v24
    v_subrev_u32 v25, 0x10000, v25
    v_subrev_u32 v26, 0x10000, v26
    v_subrev_u32 v27, 0x10000, v27
    ds_read_b128 v[84:87], v16 offset:0
    ds_read_b128 v[88:91], v17 offset:0
    ds_read_b128 v[92:95], v18 offset:0
    ds_read_b128 v[96:99], v19 offset:0
    ds_read_b128 v[100:103], v20 offset:0
    ds_read_b128 v[104:107], v21 offset:0
    ds_read_b128 v[108:111], v22 offset:0
    ds_read_b128 v[112:115], v23 offset:0
    s_waitcnt lgkmcnt(7)
    v_mfma_f32_32x32x16_bf16 v[60:75], v[84:87], v[28:31], 0
    s_waitcnt lgkmcnt(6)
    v_mfma_f32_32x32x16_bf16 v[60:75], v[88:91], v[32:35], v[60:75]
    s_waitcnt lgkmcnt(5)
    v_mfma_f32_32x32x16_bf16 v[60:75], v[92:95], v[36:39], v[60:75]
    s_waitcnt lgkmcnt(4)
    v_mfma_f32_32x32x16_bf16 v[60:75], v[96:99], v[40:43], v[60:75]
    s_waitcnt lgkmcnt(3)
    v_mfma_f32_32x32x16_bf16 v[60:75], v[100:103], v[44:47], v[60:75]
    s_waitcnt lgkmcnt(2)
    v_mfma_f32_32x32x16_bf16 v[60:75], v[104:107], v[48:51], v[60:75]
    s_waitcnt lgkmcnt(1)
    v_mfma_f32_32x32x16_bf16 v[60:75], v[108:111], v[52:55], v[60:75]
    s_waitcnt lgkmcnt(0)
    v_mfma_f32_32x32x16_bf16 v[60:75], v[112:115], v[56:59], v[60:75]
    ds_read_b64_tr_b16 v[116:117], v24 offset:16384
    ds_read_b64_tr_b16 v[118:119], v24 offset:18432
    ds_read_b64_tr_b16 v[120:121], v25 offset:16384
    ds_read_b64_tr_b16 v[122:123], v25 offset:18432
    ds_read_b64_tr_b16 v[124:125], v26 offset:16384
    ds_read_b64_tr_b16 v[126:127], v26 offset:18432
    ds_read_b64_tr_b16 v[128:129], v27 offset:16384
    ds_read_b64_tr_b16 v[130:131], v27 offset:18432
    ds_read_b64_tr_b16 v[132:133], v24 offset:20480
    ds_read_b64_tr_b16 v[134:135], v24 offset:22528
    ds_read_b64_tr_b16 v[136:137], v25 offset:20480
    ds_read_b64_tr_b16 v[138:139], v25 offset:22528
    ds_read_b64_tr_b16 v[140:141], v26 offset:20480
    ds_read_b64_tr_b16 v[142:143], v26 offset:22528
    ds_read_b64_tr_b16 v[144:145], v27 offset:20480
    ds_read_b64_tr_b16 v[146:147], v27 offset:22528
    s_nop 7
    s_nop 3
    v_max3_f32 v7, v60, v61, v62
    v_max3_f32 v7, v7, v63, v64
    v_max3_f32 v7, v7, v65, v66
    v_max3_f32 v7, v7, v67, v68
    v_max3_f32 v7, v7, v69, v70
    v_max3_f32 v7, v7, v71, v72
    v_max3_f32 v7, v7, v73, v74
    v_max_f32 v7, v7, v75
    v_mov_b32 v8, v7
    s_nop 1
    v_permlane32_swap_b32 v7, v8
    v_max_f32 v7, v7, v8
    v_mul_f32 v7, s36, v7
    v_max_f32 v7, v7, v11
    v_sub_f32 v13, v11, v7
    v_exp_f32 v13, v13
    v_mov_b32 v11, v7
    v_fma_f32 v60, v60, s36, -v11
    v_exp_f32 v60, v60
    v_fma_f32 v61, v61, s36, -v11
    v_exp_f32 v61, v61
    v_fma_f32 v62, v62, s36, -v11
    v_exp_f32 v62, v62
    v_fma_f32 v63, v63, s36, -v11
    v_exp_f32 v63, v63
    v_fma_f32 v64, v64, s36, -v11
    v_exp_f32 v64, v64
    v_fma_f32 v65, v65, s36, -v11
    v_exp_f32 v65, v65
    v_fma_f32 v66, v66, s36, -v11
    v_exp_f32 v66, v66
    v_fma_f32 v67, v67, s36, -v11
    v_exp_f32 v67, v67
    v_fma_f32 v68, v68, s36, -v11
    v_exp_f32 v68, v68
    v_fma_f32 v69, v69, s36, -v11
    v_exp_f32 v69, v69
    v_fma_f32 v70, v70, s36, -v11
    v_exp_f32 v70, v70
    v_fma_f32 v71, v71, s36, -v11
    v_exp_f32 v71, v71
    v_fma_f32 v72, v72, s36, -v11
    v_exp_f32 v72, v72
    v_fma_f32 v73, v73, s36, -v11
    v_exp_f32 v73, v73
    v_fma_f32 v74, v74, s36, -v11
    v_exp_f32 v74, v74
    v_fma_f32 v75, v75, s36, -v11
    v_exp_f32 v75, v75
    v_mul_f32 v12, v12, v13
    v_add_f32 v12, v12, v60
    v_add_f32 v12, v12, v61
    v_add_f32 v12, v12, v62
    v_add_f32 v12, v12, v63
    v_add_f32 v12, v12, v64
    v_add_f32 v12, v12, v65
    v_add_f32 v12, v12, v66
    v_add_f32 v12, v12, v67
    v_add_f32 v12, v12, v68
    v_add_f32 v12, v12, v69
    v_add_f32 v12, v12, v70
    v_add_f32 v12, v12, v71
    v_add_f32 v12, v12, v72
    v_add_f32 v12, v12, v73
    v_add_f32 v12, v12, v74
    v_add_f32 v12, v12, v75
    v_cvt_pk_bf16_f32 v76, v60, v61
    v_cvt_pk_bf16_f32 v77, v62, v63
    v_cvt_pk_bf16_f32 v78, v64, v65
    v_cvt_pk_bf16_f32 v79, v66, v67
    v_cvt_pk_bf16_f32 v80, v68, v69
    v_cvt_pk_bf16_f32 v81, v70, v71
    v_cvt_pk_bf16_f32 v82, v72, v73
    v_cvt_pk_bf16_f32 v83, v74, v75
    v_mul_f32 v148, v13, v148
    v_mul_f32 v149, v13, v149
    v_mul_f32 v150, v13, v150
    v_mul_f32 v151, v13, v151
    v_mul_f32 v152, v13, v152
    v_mul_f32 v153, v13, v153
    v_mul_f32 v154, v13, v154
    v_mul_f32 v155, v13, v155
    v_mul_f32 v156, v13, v156
    v_mul_f32 v157, v13, v157
    v_mul_f32 v158, v13, v158
    v_mul_f32 v159, v13, v159
    v_mul_f32 v160, v13, v160
    v_mul_f32 v161, v13, v161
    v_mul_f32 v162, v13, v162
    v_mul_f32 v163, v13, v163
    v_mul_f32 v164, v13, v164
    v_mul_f32 v165, v13, v165
    v_mul_f32 v166, v13, v166
    v_mul_f32 v167, v13, v167
    v_mul_f32 v168, v13, v168
    v_mul_f32 v169, v13, v169
    v_mul_f32 v170, v13, v170
    v_mul_f32 v171, v13, v171
    v_mul_f32 v172, v13, v172
    v_mul_f32 v173, v13, v173
    v_mul_f32 v174, v13, v174
    v_mul_f32 v175, v13, v175
    v_mul_f32 v176, v13, v176
    v_mul_f32 v177, v13, v177
    v_mul_f32 v178, v13, v178
    v_mul_f32 v179, v13, v179
    v_mul_f32 v180, v13, v180
    v_mul_f32 v181, v13, v181
    v_mul_f32 v182, v13, v182
    v_mul_f32 v183, v13, v183
    v_mul_f32 v184, v13, v184
    v_mul_f32 v185, v13, v185
    v_mul_f32 v186, v13, v186
    v_mul_f32 v187, v13, v187
    v_mul_f32 v188, v13, v188
    v_mul_f32 v189, v13, v189
    v_mul_f32 v190, v13, v190
    v_mul_f32 v191, v13, v191
    v_mul_f32 v192, v13, v192
    v_mul_f32 v193, v13, v193
    v_mul_f32 v194, v13, v194
    v_mul_f32 v195, v13, v195
    v_mul_f32 v196, v13, v196
    v_mul_f32 v197, v13, v197
    v_mul_f32 v198, v13, v198
    v_mul_f32 v199, v13, v199
    v_mul_f32 v200, v13, v200
    v_mul_f32 v201, v13, v201
    v_mul_f32 v202, v13, v202
    v_mul_f32 v203, v13, v203
    v_mul_f32 v204, v13, v204
    v_mul_f32 v205, v13, v205
    v_mul_f32 v206, v13, v206
    v_mul_f32 v207, v13, v207
    v_mul_f32 v208, v13, v208
    v_mul_f32 v209, v13, v209
    v_mul_f32 v210, v13, v210
    v_mul_f32 v211, v13, v211
    s_waitcnt lgkmcnt(0)
    v_mfma_f32_32x32x16_bf16 v[148:163], v[116:119], v[76:79], v[148:163]
    v_mfma_f32_32x32x16_bf16 v[164:179], v[120:123], v[76:79], v[164:179]
    v_mfma_f32_32x32x16_bf16 v[180:195], v[124:127], v[76:79], v[180:195]
    v_mfma_f32_32x32x16_bf16 v[196:211], v[128:131], v[76:79], v[196:211]
    v_mfma_f32_32x32x16_bf16 v[148:163], v[132:135], v[80:83], v[148:163]
    v_mfma_f32_32x32x16_bf16 v[164:179], v[136:139], v[80:83], v[164:179]
    v_mfma_f32_32x32x16_bf16 v[180:195], v[140:143], v[80:83], v[180:195]
    v_mfma_f32_32x32x16_bf16 v[196:211], v[144:147], v[80:83], v[196:211]
    s_waitcnt vmcnt(8)
    s_barrier
    s_lshl_b32 s30, s3, 11
    s_add_u32 s30, s30, 0
    s_mov_b32 s31, 196608
    s_mov_b32 m0, s30
    s_add_u32 s30, s30, 1024
    buffer_load_dwordx4 v4, s[8:11], s31 offen lds
    s_mov_b32 m0, s30
    s_add_u32 s30, s30, 15360
    buffer_load_dwordx4 v5, s[8:11], s31 offen lds
    s_mov_b32 m0, s30
    s_nop 0
    buffer_load_dwordx4 v6, s[12:15], s31 offen lds
    buffer_load_dwordx4 v6, s[12:15], s31 offen offset:1024 lds
    ds_read_b128 v[84:87], v16 offset:32768
    ds_read_b128 v[88:91], v17 offset:32768
    ds_read_b128 v[92:95], v18 offset:32768
    ds_read_b128 v[96:99], v19 offset:32768
    ds_read_b128 v[100:103], v20 offset:32768
    ds_read_b128 v[104:107], v21 offset:32768
    ds_read_b128 v[108:111], v22 offset:32768
    ds_read_b128 v[112:115], v23 offset:32768
    s_waitcnt lgkmcnt(7)
    v_mfma_f32_32x32x16_bf16 v[60:75], v[84:87], v[28:31], 0
    s_waitcnt lgkmcnt(6)
    v_mfma_f32_32x32x16_bf16 v[60:75], v[88:91], v[32:35], v[60:75]
    s_waitcnt lgkmcnt(5)
    v_mfma_f32_32x32x16_bf16 v[60:75], v[92:95], v[36:39], v[60:75]
    s_waitcnt lgkmcnt(4)
    v_mfma_f32_32x32x16_bf16 v[60:75], v[96:99], v[40:43], v[60:75]
    s_waitcnt lgkmcnt(3)
    v_mfma_f32_32x32x16_bf16 v[60:75], v[100:103], v[44:47], v[60:75]
    s_waitcnt lgkmcnt(2)
    v_mfma_f32_32x32x16_bf16 v[60:75], v[104:107], v[48:51], v[60:75]
    s_waitcnt lgkmcnt(1)
    v_mfma_f32_32x32x16_bf16 v[60:75], v[108:111], v[52:55], v[60:75]
    s_waitcnt lgkmcnt(0)
    v_mfma_f32_32x32x16_bf16 v[60:75], v[112:115], v[56:59], v[60:75]
    ds_read_b64_tr_b16 v[116:117], v24 offset:49152
    ds_read_b64_tr_b16 v[118:119], v24 offset:51200
    ds_read_b64_tr_b16 v[120:121], v25 offset:49152
    ds_read_b64_tr_b16 v[122:123], v25 offset:51200
    ds_read_b64_tr_b16 v[124:125], v26 offset:49152
    ds_read_b64_tr_b16 v[126:127], v26 offset:51200
    ds_read_b64_tr_b16 v[128:129], v27 offset:49152
    ds_read_b64_tr_b16 v[130:131], v27 offset:51200
    ds_read_b64_tr_b16 v[132:133], v24 offset:53248
    ds_read_b64_tr_b16 v[134:135], v24 offset:55296
    ds_read_b64_tr_b16 v[136:137], v25 offset:53248
    ds_read_b64_tr_b16 v[138:139], v25 offset:55296
    ds_read_b64_tr_b16 v[140:141], v26 offset:53248
    ds_read_b64_tr_b16 v[142:143], v26 offset:55296
    ds_read_b64_tr_b16 v[144:145], v27 offset:53248
    ds_read_b64_tr_b16 v[146:147], v27 offset:55296
    s_nop 7
    s_nop 3
    v_max3_f32 v7, v60, v61, v62
    v_max3_f32 v7, v7, v63, v64
    v_max3_f32 v7, v7, v65, v66
    v_max3_f32 v7, v7, v67, v68
    v_max3_f32 v7, v7, v69, v70
    v_max3_f32 v7, v7, v71, v72
    v_max3_f32 v7, v7, v73, v74
    v_max_f32 v7, v7, v75
    v_mov_b32 v8, v7
    s_nop 1
    v_permlane32_swap_b32 v7, v8
    v_max_f32 v7, v7, v8
    v_mul_f32 v7, s36, v7
    v_max_f32 v7, v7, v11
    v_sub_f32 v13, v11, v7
    v_exp_f32 v13, v13
    v_mov_b32 v11, v7
    v_fma_f32 v60, v60, s36, -v11
    v_exp_f32 v60, v60
    v_fma_f32 v61, v61, s36, -v11
    v_exp_f32 v61, v61
    v_fma_f32 v62, v62, s36, -v11
    v_exp_f32 v62, v62
    v_fma_f32 v63, v63, s36, -v11
    v_exp_f32 v63, v63
    v_fma_f32 v64, v64, s36, -v11
    v_exp_f32 v64, v64
    v_fma_f32 v65, v65, s36, -v11
    v_exp_f32 v65, v65
    v_fma_f32 v66, v66, s36, -v11
    v_exp_f32 v66, v66
    v_fma_f32 v67, v67, s36, -v11
    v_exp_f32 v67, v67
    v_fma_f32 v68, v68, s36, -v11
    v_exp_f32 v68, v68
    v_fma_f32 v69, v69, s36, -v11
    v_exp_f32 v69, v69
    v_fma_f32 v70, v70, s36, -v11
    v_exp_f32 v70, v70
    v_fma_f32 v71, v71, s36, -v11
    v_exp_f32 v71, v71
    v_fma_f32 v72, v72, s36, -v11
    v_exp_f32 v72, v72
    v_fma_f32 v73, v73, s36, -v11
    v_exp_f32 v73, v73
    v_fma_f32 v74, v74, s36, -v11
    v_exp_f32 v74, v74
    v_fma_f32 v75, v75, s36, -v11
    v_exp_f32 v75, v75
    v_mul_f32 v12, v12, v13
    v_add_f32 v12, v12, v60
    v_add_f32 v12, v12, v61
    v_add_f32 v12, v12, v62
    v_add_f32 v12, v12, v63
    v_add_f32 v12, v12, v64
    v_add_f32 v12, v12, v65
    v_add_f32 v12, v12, v66
    v_add_f32 v12, v12, v67
    v_add_f32 v12, v12, v68
    v_add_f32 v12, v12, v69
    v_add_f32 v12, v12, v70
    v_add_f32 v12, v12, v71
    v_add_f32 v12, v12, v72
    v_add_f32 v12, v12, v73
    v_add_f32 v12, v12, v74
    v_add_f32 v12, v12, v75
    v_cvt_pk_bf16_f32 v76, v60, v61
    v_cvt_pk_bf16_f32 v77, v62, v63
    v_cvt_pk_bf16_f32 v78, v64, v65
    v_cvt_pk_bf16_f32 v79, v66, v67
    v_cvt_pk_bf16_f32 v80, v68, v69
    v_cvt_pk_bf16_f32 v81, v70, v71
    v_cvt_pk_bf16_f32 v82, v72, v73
    v_cvt_pk_bf16_f32 v83, v74, v75
    v_mul_f32 v148, v13, v148
    v_mul_f32 v149, v13, v149
    v_mul_f32 v150, v13, v150
    v_mul_f32 v151, v13, v151
    v_mul_f32 v152, v13, v152
    v_mul_f32 v153, v13, v153
    v_mul_f32 v154, v13, v154
    v_mul_f32 v155, v13, v155
    v_mul_f32 v156, v13, v156
    v_mul_f32 v157, v13, v157
    v_mul_f32 v158, v13, v158
    v_mul_f32 v159, v13, v159
    v_mul_f32 v160, v13, v160
    v_mul_f32 v161, v13, v161
    v_mul_f32 v162, v13, v162
    v_mul_f32 v163, v13, v163
    v_mul_f32 v164, v13, v164
    v_mul_f32 v165, v13, v165
    v_mul_f32 v166, v13, v166
    v_mul_f32 v167, v13, v167
    v_mul_f32 v168, v13, v168
    v_mul_f32 v169, v13, v169
    v_mul_f32 v170, v13, v170
    v_mul_f32 v171, v13, v171
    v_mul_f32 v172, v13, v172
    v_mul_f32 v173, v13, v173
    v_mul_f32 v174, v13, v174
    v_mul_f32 v175, v13, v175
    v_mul_f32 v176, v13, v176
    v_mul_f32 v177, v13, v177
    v_mul_f32 v178, v13, v178
    v_mul_f32 v179, v13, v179
    v_mul_f32 v180, v13, v180
    v_mul_f32 v181, v13, v181
    v_mul_f32 v182, v13, v182
    v_mul_f32 v183, v13, v183
    v_mul_f32 v184, v13, v184
    v_mul_f32 v185, v13, v185
    v_mul_f32 v186, v13, v186
    v_mul_f32 v187, v13, v187
    v_mul_f32 v188, v13, v188
    v_mul_f32 v189, v13, v189
    v_mul_f32 v190, v13, v190
    v_mul_f32 v191, v13, v191
    v_mul_f32 v192, v13, v192
    v_mul_f32 v193, v13, v193
    v_mul_f32 v194, v13, v194
    v_mul_f32 v195, v13, v195
    v_mul_f32 v196, v13, v196
    v_mul_f32 v197, v13, v197
    v_mul_f32 v198, v13, v198
    v_mul_f32 v199, v13, v199
    v_mul_f32 v200, v13, v200
    v_mul_f32 v201, v13, v201
    v_mul_f32 v202, v13, v202
    v_mul_f32 v203, v13, v203
    v_mul_f32 v204, v13, v204
    v_mul_f32 v205, v13, v205
    v_mul_f32 v206, v13, v206
    v_mul_f32 v207, v13, v207
    v_mul_f32 v208, v13, v208
    v_mul_f32 v209, v13, v209
    v_mul_f32 v210, v13, v210
    v_mul_f32 v211, v13, v211
    s_waitcnt lgkmcnt(0)
    v_mfma_f32_32x32x16_bf16 v[148:163], v[116:119], v[76:79], v[148:163]
    v_mfma_f32_32x32x16_bf16 v[164:179], v[120:123], v[76:79], v[164:179]
    v_mfma_f32_32x32x16_bf16 v[180:195], v[124:127], v[76:79], v[180:195]
    v_mfma_f32_32x32x16_bf16 v[196:211], v[128:131], v[76:79], v[196:211]
    v_mfma_f32_32x32x16_bf16 v[148:163], v[132:135], v[80:83], v[148:163]
    v_mfma_f32_32x32x16_bf16 v[164:179], v[136:139], v[80:83], v[164:179]
    v_mfma_f32_32x32x16_bf16 v[180:195], v[140:143], v[80:83], v[180:195]
    v_mfma_f32_32x32x16_bf16 v[196:211], v[144:147], v[80:83], v[196:211]
    s_waitcnt vmcnt(8)
    s_barrier
    s_lshl_b32 s30, s3, 11
    s_add_u32 s30, s30, 32768
    s_mov_b32 s31, 212992
    s_mov_b32 m0, s30
    s_add_u32 s30, s30, 1024
    buffer_load_dwordx4 v4, s[8:11], s31 offen lds
    s_mov_b32 m0, s30
    s_add_u32 s30, s30, 15360
    buffer_load_dwordx4 v5, s[8:11], s31 offen lds
    s_mov_b32 m0, s30
    s_nop 0
    buffer_load_dwordx4 v6, s[12:15], s31 offen lds
    buffer_load_dwordx4 v6, s[12:15], s31 offen offset:1024 lds
    v_add_u32 v16, 0x10000, v16
    v_add_u32 v17, 0x10000, v17
    v_add_u32 v18, 0x10000, v18
    v_add_u32 v19, 0x10000, v19
    v_add_u32 v20, 0x10000, v20
    v_add_u32 v21, 0x10000, v21
    v_add_u32 v22, 0x10000, v22
    v_add_u32 v23, 0x10000, v23
    v_add_u32 v24, 0x10000, v24
    v_add_u32 v25, 0x10000, v25
    v_add_u32 v26, 0x10000, v26
    v_add_u32 v27, 0x10000, v27
    ds_read_b128 v[84:87], v16 offset:0
    ds_read_b128 v[88:91], v17 offset:0
    ds_read_b128 v[92:95], v18 offset:0
    ds_read_b128 v[96:99], v19 offset:0
    ds_read_b128 v[100:103], v20 offset:0
    ds_read_b128 v[104:107], v21 offset:0
    ds_read_b128 v[108:111], v22 offset:0
    ds_read_b128 v[112:115], v23 offset:0
    s_waitcnt lgkmcnt(7)
    v_mfma_f32_32x32x16_bf16 v[60:75], v[84:87], v[28:31], 0
    s_waitcnt lgkmcnt(6)
    v_mfma_f32_32x32x16_bf16 v[60:75], v[88:91], v[32:35], v[60:75]
    s_waitcnt lgkmcnt(5)
    v_mfma_f32_32x32x16_bf16 v[60:75], v[92:95], v[36:39], v[60:75]
    s_waitcnt lgkmcnt(4)
    v_mfma_f32_32x32x16_bf16 v[60:75], v[96:99], v[40:43], v[60:75]
    s_waitcnt lgkmcnt(3)
    v_mfma_f32_32x32x16_bf16 v[60:75], v[100:103], v[44:47], v[60:75]
    s_waitcnt lgkmcnt(2)
    v_mfma_f32_32x32x16_bf16 v[60:75], v[104:107], v[48:51], v[60:75]
    s_waitcnt lgkmcnt(1)
    v_mfma_f32_32x32x16_bf16 v[60:75], v[108:111], v[52:55], v[60:75]
    s_waitcnt lgkmcnt(0)
    v_mfma_f32_32x32x16_bf16 v[60:75], v[112:115], v[56:59], v[60:75]
    ds_read_b64_tr_b16 v[116:117], v24 offset:16384
    ds_read_b64_tr_b16 v[118:119], v24 offset:18432
    ds_read_b64_tr_b16 v[120:121], v25 offset:16384
    ds_read_b64_tr_b16 v[122:123], v25 offset:18432
    ds_read_b64_tr_b16 v[124:125], v26 offset:16384
    ds_read_b64_tr_b16 v[126:127], v26 offset:18432
    ds_read_b64_tr_b16 v[128:129], v27 offset:16384
    ds_read_b64_tr_b16 v[130:131], v27 offset:18432
    ds_read_b64_tr_b16 v[132:133], v24 offset:20480
    ds_read_b64_tr_b16 v[134:135], v24 offset:22528
    ds_read_b64_tr_b16 v[136:137], v25 offset:20480
    ds_read_b64_tr_b16 v[138:139], v25 offset:22528
    ds_read_b64_tr_b16 v[140:141], v26 offset:20480
    ds_read_b64_tr_b16 v[142:143], v26 offset:22528
    ds_read_b64_tr_b16 v[144:145], v27 offset:20480
    ds_read_b64_tr_b16 v[146:147], v27 offset:22528
    s_nop 7
    s_nop 3
    v_max3_f32 v7, v60, v61, v62
    v_max3_f32 v7, v7, v63, v64
    v_max3_f32 v7, v7, v65, v66
    v_max3_f32 v7, v7, v67, v68
    v_max3_f32 v7, v7, v69, v70
    v_max3_f32 v7, v7, v71, v72
    v_max3_f32 v7, v7, v73, v74
    v_max_f32 v7, v7, v75
    v_mov_b32 v8, v7
    s_nop 1
    v_permlane32_swap_b32 v7, v8
    v_max_f32 v7, v7, v8
    v_mul_f32 v7, s36, v7
    v_max_f32 v7, v7, v11
    v_sub_f32 v13, v11, v7
    v_exp_f32 v13, v13
    v_mov_b32 v11, v7
    v_fma_f32 v60, v60, s36, -v11
    v_exp_f32 v60, v60
    v_fma_f32 v61, v61, s36, -v11
    v_exp_f32 v61, v61
    v_fma_f32 v62, v62, s36, -v11
    v_exp_f32 v62, v62
    v_fma_f32 v63, v63, s36, -v11
    v_exp_f32 v63, v63
    v_fma_f32 v64, v64, s36, -v11
    v_exp_f32 v64, v64
    v_fma_f32 v65, v65, s36, -v11
    v_exp_f32 v65, v65
    v_fma_f32 v66, v66, s36, -v11
    v_exp_f32 v66, v66
    v_fma_f32 v67, v67, s36, -v11
    v_exp_f32 v67, v67
    v_fma_f32 v68, v68, s36, -v11
    v_exp_f32 v68, v68
    v_fma_f32 v69, v69, s36, -v11
    v_exp_f32 v69, v69
    v_fma_f32 v70, v70, s36, -v11
    v_exp_f32 v70, v70
    v_fma_f32 v71, v71, s36, -v11
    v_exp_f32 v71, v71
    v_fma_f32 v72, v72, s36, -v11
    v_exp_f32 v72, v72
    v_fma_f32 v73, v73, s36, -v11
    v_exp_f32 v73, v73
    v_fma_f32 v74, v74, s36, -v11
    v_exp_f32 v74, v74
    v_fma_f32 v75, v75, s36, -v11
    v_exp_f32 v75, v75
    v_mul_f32 v12, v12, v13
    v_add_f32 v12, v12, v60
    v_add_f32 v12, v12, v61
    v_add_f32 v12, v12, v62
    v_add_f32 v12, v12, v63
    v_add_f32 v12, v12, v64
    v_add_f32 v12, v12, v65
    v_add_f32 v12, v12, v66
    v_add_f32 v12, v12, v67
    v_add_f32 v12, v12, v68
    v_add_f32 v12, v12, v69
    v_add_f32 v12, v12, v70
    v_add_f32 v12, v12, v71
    v_add_f32 v12, v12, v72
    v_add_f32 v12, v12, v73
    v_add_f32 v12, v12, v74
    v_add_f32 v12, v12, v75
    v_cvt_pk_bf16_f32 v76, v60, v61
    v_cvt_pk_bf16_f32 v77, v62, v63
    v_cvt_pk_bf16_f32 v78, v64, v65
    v_cvt_pk_bf16_f32 v79, v66, v67
    v_cvt_pk_bf16_f32 v80, v68, v69
    v_cvt_pk_bf16_f32 v81, v70, v71
    v_cvt_pk_bf16_f32 v82, v72, v73
    v_cvt_pk_bf16_f32 v83, v74, v75
    v_mul_f32 v148, v13, v148
    v_mul_f32 v149, v13, v149
    v_mul_f32 v150, v13, v150
    v_mul_f32 v151, v13, v151
    v_mul_f32 v152, v13, v152
    v_mul_f32 v153, v13, v153
    v_mul_f32 v154, v13, v154
    v_mul_f32 v155, v13, v155
    v_mul_f32 v156, v13, v156
    v_mul_f32 v157, v13, v157
    v_mul_f32 v158, v13, v158
    v_mul_f32 v159, v13, v159
    v_mul_f32 v160, v13, v160
    v_mul_f32 v161, v13, v161
    v_mul_f32 v162, v13, v162
    v_mul_f32 v163, v13, v163
    v_mul_f32 v164, v13, v164
    v_mul_f32 v165, v13, v165
    v_mul_f32 v166, v13, v166
    v_mul_f32 v167, v13, v167
    v_mul_f32 v168, v13, v168
    v_mul_f32 v169, v13, v169
    v_mul_f32 v170, v13, v170
    v_mul_f32 v171, v13, v171
    v_mul_f32 v172, v13, v172
    v_mul_f32 v173, v13, v173
    v_mul_f32 v174, v13, v174
    v_mul_f32 v175, v13, v175
    v_mul_f32 v176, v13, v176
    v_mul_f32 v177, v13, v177
    v_mul_f32 v178, v13, v178
    v_mul_f32 v179, v13, v179
    v_mul_f32 v180, v13, v180
    v_mul_f32 v181, v13, v181
    v_mul_f32 v182, v13, v182
    v_mul_f32 v183, v13, v183
    v_mul_f32 v184, v13, v184
    v_mul_f32 v185, v13, v185
    v_mul_f32 v186, v13, v186
    v_mul_f32 v187, v13, v187
    v_mul_f32 v188, v13, v188
    v_mul_f32 v189, v13, v189
    v_mul_f32 v190, v13, v190
    v_mul_f32 v191, v13, v191
    v_mul_f32 v192, v13, v192
    v_mul_f32 v193, v13, v193
    v_mul_f32 v194, v13, v194
    v_mul_f32 v195, v13, v195
    v_mul_f32 v196, v13, v196
    v_mul_f32 v197, v13, v197
    v_mul_f32 v198, v13, v198
    v_mul_f32 v199, v13, v199
    v_mul_f32 v200, v13, v200
    v_mul_f32 v201, v13, v201
    v_mul_f32 v202, v13, v202
    v_mul_f32 v203, v13, v203
    v_mul_f32 v204, v13, v204
    v_mul_f32 v205, v13, v205
    v_mul_f32 v206, v13, v206
    v_mul_f32 v207, v13, v207
    v_mul_f32 v208, v13, v208
    v_mul_f32 v209, v13, v209
    v_mul_f32 v210, v13, v210
    v_mul_f32 v211, v13, v211
    s_waitcnt lgkmcnt(0)
    v_mfma_f32_32x32x16_bf16 v[148:163], v[116:119], v[76:79], v[148:163]
    v_mfma_f32_32x32x16_bf16 v[164:179], v[120:123], v[76:79], v[164:179]
    v_mfma_f32_32x32x16_bf16 v[180:195], v[124:127], v[76:79], v[180:195]
    v_mfma_f32_32x32x16_bf16 v[196:211], v[128:131], v[76:79], v[196:211]
    v_mfma_f32_32x32x16_bf16 v[148:163], v[132:135], v[80:83], v[148:163]
    v_mfma_f32_32x32x16_bf16 v[164:179], v[136:139], v[80:83], v[164:179]
    v_mfma_f32_32x32x16_bf16 v[180:195], v[140:143], v[80:83], v[180:195]
    v_mfma_f32_32x32x16_bf16 v[196:211], v[144:147], v[80:83], v[196:211]
    s_waitcnt vmcnt(8)
    s_barrier
    s_lshl_b32 s30, s3, 11
    s_add_u32 s30, s30, 65536
    s_mov_b32 s31, 229376
    s_mov_b32 m0, s30
    s_add_u32 s30, s30, 1024
    buffer_load_dwordx4 v4, s[8:11], s31 offen lds
    s_mov_b32 m0, s30
    s_add_u32 s30, s30, 15360
    buffer_load_dwordx4 v5, s[8:11], s31 offen lds
    s_mov_b32 m0, s30
    s_nop 0
    buffer_load_dwordx4 v6, s[12:15], s31 offen lds
    buffer_load_dwordx4 v6, s[12:15], s31 offen offset:1024 lds
    ds_read_b128 v[84:87], v16 offset:32768
    ds_read_b128 v[88:91], v17 offset:32768
    ds_read_b128 v[92:95], v18 offset:32768
    ds_read_b128 v[96:99], v19 offset:32768
    ds_read_b128 v[100:103], v20 offset:32768
    ds_read_b128 v[104:107], v21 offset:32768
    ds_read_b128 v[108:111], v22 offset:32768
    ds_read_b128 v[112:115], v23 offset:32768
    s_waitcnt lgkmcnt(7)
    v_mfma_f32_32x32x16_bf16 v[60:75], v[84:87], v[28:31], 0
    s_waitcnt lgkmcnt(6)
    v_mfma_f32_32x32x16_bf16 v[60:75], v[88:91], v[32:35], v[60:75]
    s_waitcnt lgkmcnt(5)
    v_mfma_f32_32x32x16_bf16 v[60:75], v[92:95], v[36:39], v[60:75]
    s_waitcnt lgkmcnt(4)
    v_mfma_f32_32x32x16_bf16 v[60:75], v[96:99], v[40:43], v[60:75]
    s_waitcnt lgkmcnt(3)
    v_mfma_f32_32x32x16_bf16 v[60:75], v[100:103], v[44:47], v[60:75]
    s_waitcnt lgkmcnt(2)
    v_mfma_f32_32x32x16_bf16 v[60:75], v[104:107], v[48:51], v[60:75]
    s_waitcnt lgkmcnt(1)
    v_mfma_f32_32x32x16_bf16 v[60:75], v[108:111], v[52:55], v[60:75]
    s_waitcnt lgkmcnt(0)
    v_mfma_f32_32x32x16_bf16 v[60:75], v[112:115], v[56:59], v[60:75]
    ds_read_b64_tr_b16 v[116:117], v24 offset:49152
    ds_read_b64_tr_b16 v[118:119], v24 offset:51200
    ds_read_b64_tr_b16 v[120:121], v25 offset:49152
    ds_read_b64_tr_b16 v[122:123], v25 offset:51200
    ds_read_b64_tr_b16 v[124:125], v26 offset:49152
    ds_read_b64_tr_b16 v[126:127], v26 offset:51200
    ds_read_b64_tr_b16 v[128:129], v27 offset:49152
    ds_read_b64_tr_b16 v[130:131], v27 offset:51200
    ds_read_b64_tr_b16 v[132:133], v24 offset:53248
    ds_read_b64_tr_b16 v[134:135], v24 offset:55296
    ds_read_b64_tr_b16 v[136:137], v25 offset:53248
    ds_read_b64_tr_b16 v[138:139], v25 offset:55296
    ds_read_b64_tr_b16 v[140:141], v26 offset:53248
    ds_read_b64_tr_b16 v[142:143], v26 offset:55296
    ds_read_b64_tr_b16 v[144:145], v27 offset:53248
    ds_read_b64_tr_b16 v[146:147], v27 offset:55296
    s_nop 7
    s_nop 3
    v_max3_f32 v7, v60, v61, v62
    v_max3_f32 v7, v7, v63, v64
    v_max3_f32 v7, v7, v65, v66
    v_max3_f32 v7, v7, v67, v68
    v_max3_f32 v7, v7, v69, v70
    v_max3_f32 v7, v7, v71, v72
    v_max3_f32 v7, v7, v73, v74
    v_max_f32 v7, v7, v75
    v_mov_b32 v8, v7
    s_nop 1
    v_permlane32_swap_b32 v7, v8
    v_max_f32 v7, v7, v8
    v_mul_f32 v7, s36, v7
    v_max_f32 v7, v7, v11
    v_sub_f32 v13, v11, v7
    v_exp_f32 v13, v13
    v_mov_b32 v11, v7
    v_fma_f32 v60, v60, s36, -v11
    v_exp_f32 v60, v60
    v_fma_f32 v61, v61, s36, -v11
    v_exp_f32 v61, v61
    v_fma_f32 v62, v62, s36, -v11
    v_exp_f32 v62, v62
    v_fma_f32 v63, v63, s36, -v11
    v_exp_f32 v63, v63
    v_fma_f32 v64, v64, s36, -v11
    v_exp_f32 v64, v64
    v_fma_f32 v65, v65, s36, -v11
    v_exp_f32 v65, v65
    v_fma_f32 v66, v66, s36, -v11
    v_exp_f32 v66, v66
    v_fma_f32 v67, v67, s36, -v11
    v_exp_f32 v67, v67
    v_fma_f32 v68, v68, s36, -v11
    v_exp_f32 v68, v68
    v_fma_f32 v69, v69, s36, -v11
    v_exp_f32 v69, v69
    v_fma_f32 v70, v70, s36, -v11
    v_exp_f32 v70, v70
    v_fma_f32 v71, v71, s36, -v11
    v_exp_f32 v71, v71
    v_fma_f32 v72, v72, s36, -v11
    v_exp_f32 v72, v72
    v_fma_f32 v73, v73, s36, -v11
    v_exp_f32 v73, v73
    v_fma_f32 v74, v74, s36, -v11
    v_exp_f32 v74, v74
    v_fma_f32 v75, v75, s36, -v11
    v_exp_f32 v75, v75
    v_mul_f32 v12, v12, v13
    v_add_f32 v12, v12, v60
    v_add_f32 v12, v12, v61
    v_add_f32 v12, v12, v62
    v_add_f32 v12, v12, v63
    v_add_f32 v12, v12, v64
    v_add_f32 v12, v12, v65
    v_add_f32 v12, v12, v66
    v_add_f32 v12, v12, v67
    v_add_f32 v12, v12, v68
    v_add_f32 v12, v12, v69
    v_add_f32 v12, v12, v70
    v_add_f32 v12, v12, v71
    v_add_f32 v12, v12, v72
    v_add_f32 v12, v12, v73
    v_add_f32 v12, v12, v74
    v_add_f32 v12, v12, v75
    v_cvt_pk_bf16_f32 v76, v60, v61
    v_cvt_pk_bf16_f32 v77, v62, v63
    v_cvt_pk_bf16_f32 v78, v64, v65
    v_cvt_pk_bf16_f32 v79, v66, v67
    v_cvt_pk_bf16_f32 v80, v68, v69
    v_cvt_pk_bf16_f32 v81, v70, v71
    v_cvt_pk_bf16_f32 v82, v72, v73
    v_cvt_pk_bf16_f32 v83, v74, v75
    v_mul_f32 v148, v13, v148
    v_mul_f32 v149, v13, v149
    v_mul_f32 v150, v13, v150
    v_mul_f32 v151, v13, v151
    v_mul_f32 v152, v13, v152
    v_mul_f32 v153, v13, v153
    v_mul_f32 v154, v13, v154
    v_mul_f32 v155, v13, v155
    v_mul_f32 v156, v13, v156
    v_mul_f32 v157, v13, v157
    v_mul_f32 v158, v13, v158
    v_mul_f32 v159, v13, v159
    v_mul_f32 v160, v13, v160
    v_mul_f32 v161, v13, v161
    v_mul_f32 v162, v13, v162
    v_mul_f32 v163, v13, v163
    v_mul_f32 v164, v13, v164
    v_mul_f32 v165, v13, v165
    v_mul_f32 v166, v13, v166
    v_mul_f32 v167, v13, v167
    v_mul_f32 v168, v13, v168
    v_mul_f32 v169, v13, v169
    v_mul_f32 v170, v13, v170
    v_mul_f32 v171, v13, v171
    v_mul_f32 v172, v13, v172
    v_mul_f32 v173, v13, v173
    v_mul_f32 v174, v13, v174
    v_mul_f32 v175, v13, v175
    v_mul_f32 v176, v13, v176
    v_mul_f32 v177, v13, v177
    v_mul_f32 v178, v13, v178
    v_mul_f32 v179, v13, v179
    v_mul_f32 v180, v13, v180
    v_mul_f32 v181, v13, v181
    v_mul_f32 v182, v13, v182
    v_mul_f32 v183, v13, v183
    v_mul_f32 v184, v13, v184
    v_mul_f32 v185, v13, v185
    v_mul_f32 v186, v13, v186
    v_mul_f32 v187, v13, v187
    v_mul_f32 v188, v13, v188
    v_mul_f32 v189, v13, v189
    v_mul_f32 v190, v13, v190
    v_mul_f32 v191, v13, v191
    v_mul_f32 v192, v13, v192
    v_mul_f32 v193, v13, v193
    v_mul_f32 v194, v13, v194
    v_mul_f32 v195, v13, v195
    v_mul_f32 v196, v13, v196
    v_mul_f32 v197, v13, v197
    v_mul_f32 v198, v13, v198
    v_mul_f32 v199, v13, v199
    v_mul_f32 v200, v13, v200
    v_mul_f32 v201, v13, v201
    v_mul_f32 v202, v13, v202
    v_mul_f32 v203, v13, v203
    v_mul_f32 v204, v13, v204
    v_mul_f32 v205, v13, v205
    v_mul_f32 v206, v13, v206
    v_mul_f32 v207, v13, v207
    v_mul_f32 v208, v13, v208
    v_mul_f32 v209, v13, v209
    v_mul_f32 v210, v13, v210
    v_mul_f32 v211, v13, v211
    s_waitcnt lgkmcnt(0)
    v_mfma_f32_32x32x16_bf16 v[148:163], v[116:119], v[76:79], v[148:163]
    v_mfma_f32_32x32x16_bf16 v[164:179], v[120:123], v[76:79], v[164:179]
    v_mfma_f32_32x32x16_bf16 v[180:195], v[124:127], v[76:79], v[180:195]
    v_mfma_f32_32x32x16_bf16 v[196:211], v[128:131], v[76:79], v[196:211]
    v_mfma_f32_32x32x16_bf16 v[148:163], v[132:135], v[80:83], v[148:163]
    v_mfma_f32_32x32x16_bf16 v[164:179], v[136:139], v[80:83], v[164:179]
    v_mfma_f32_32x32x16_bf16 v[180:195], v[140:143], v[80:83], v[180:195]
    v_mfma_f32_32x32x16_bf16 v[196:211], v[144:147], v[80:83], v[196:211]
    s_waitcnt vmcnt(8)
    s_barrier
    s_lshl_b32 s30, s3, 11
    s_add_u32 s30, s30, 98304
    s_mov_b32 s31, 245760
    s_mov_b32 m0, s30
    s_add_u32 s30, s30, 1024
    buffer_load_dwordx4 v4, s[8:11], s31 offen lds
    s_mov_b32 m0, s30
    s_add_u32 s30, s30, 15360
    buffer_load_dwordx4 v5, s[8:11], s31 offen lds
    s_mov_b32 m0, s30
    s_nop 0
    buffer_load_dwordx4 v6, s[12:15], s31 offen lds
    buffer_load_dwordx4 v6, s[12:15], s31 offen offset:1024 lds
    v_subrev_u32 v16, 0x10000, v16
    v_subrev_u32 v17, 0x10000, v17
    v_subrev_u32 v18, 0x10000, v18
    v_subrev_u32 v19, 0x10000, v19
    v_subrev_u32 v20, 0x10000, v20
    v_subrev_u32 v21, 0x10000, v21
    v_subrev_u32 v22, 0x10000, v22
    v_subrev_u32 v23, 0x10000, v23
    v_subrev_u32 v24, 0x10000, v24
    v_subrev_u32 v25, 0x10000, v25
    v_subrev_u32 v26, 0x10000, v26
    v_subrev_u32 v27, 0x10000, v27
    ds_read_b128 v[84:87], v16 offset:0
    ds_read_b128 v[88:91], v17 offset:0
    ds_read_b128 v[92:95], v18 offset:0
    ds_read_b128 v[96:99], v19 offset:0
    ds_read_b128 v[100:103], v20 offset:0
    ds_read_b128 v[104:107], v21 offset:0
    ds_read_b128 v[108:111], v22 offset:0
    ds_read_b128 v[112:115], v23 offset:0
    s_waitcnt lgkmcnt(7)
    v_mfma_f32_32x32x16_bf16 v[60:75], v[84:87], v[28:31], 0
    s_waitcnt lgkmcnt(6)
    v_mfma_f32_32x32x16_bf16 v[60:75], v[88:91], v[32:35], v[60:75]
    s_waitcnt lgkmcnt(5)
    v_mfma_f32_32x32x16_bf16 v[60:75], v[92:95], v[36:39], v[60:75]
    s_waitcnt lgkmcnt(4)
    v_mfma_f32_32x32x16_bf16 v[60:75], v[96:99], v[40:43], v[60:75]
    s_waitcnt lgkmcnt(3)
    v_mfma_f32_32x32x16_bf16 v[60:75], v[100:103], v[44:47], v[60:75]
    s_waitcnt lgkmcnt(2)
    v_mfma_f32_32x32x16_bf16 v[60:75], v[104:107], v[48:51], v[60:75]
    s_waitcnt lgkmcnt(1)
    v_mfma_f32_32x32x16_bf16 v[60:75], v[108:111], v[52:55], v[60:75]
    s_waitcnt lgkmcnt(0)
    v_mfma_f32_32x32x16_bf16 v[60:75], v[112:115], v[56:59], v[60:75]
    ds_read_b64_tr_b16 v[116:117], v24 offset:16384
    ds_read_b64_tr_b16 v[118:119], v24 offset:18432
    ds_read_b64_tr_b16 v[120:121], v25 offset:16384
    ds_read_b64_tr_b16 v[122:123], v25 offset:18432
    ds_read_b64_tr_b16 v[124:125], v26 offset:16384
    ds_read_b64_tr_b16 v[126:127], v26 offset:18432
    ds_read_b64_tr_b16 v[128:129], v27 offset:16384
    ds_read_b64_tr_b16 v[130:131], v27 offset:18432
    ds_read_b64_tr_b16 v[132:133], v24 offset:20480
    ds_read_b64_tr_b16 v[134:135], v24 offset:22528
    ds_read_b64_tr_b16 v[136:137], v25 offset:20480
    ds_read_b64_tr_b16 v[138:139], v25 offset:22528
    ds_read_b64_tr_b16 v[140:141], v26 offset:20480
    ds_read_b64_tr_b16 v[142:143], v26 offset:22528
    ds_read_b64_tr_b16 v[144:145], v27 offset:20480
    ds_read_b64_tr_b16 v[146:147], v27 offset:22528
    s_nop 7
    s_nop 3
    v_max3_f32 v7, v60, v61, v62
    v_max3_f32 v7, v7, v63, v64
    v_max3_f32 v7, v7, v65, v66
    v_max3_f32 v7, v7, v67, v68
    v_max3_f32 v7, v7, v69, v70
    v_max3_f32 v7, v7, v71, v72
    v_max3_f32 v7, v7, v73, v74
    v_max_f32 v7, v7, v75
    v_mov_b32 v8, v7
    s_nop 1
    v_permlane32_swap_b32 v7, v8
    v_max_f32 v7, v7, v8
    v_mul_f32 v7, s36, v7
    v_max_f32 v7, v7, v11
    v_sub_f32 v13, v11, v7
    v_exp_f32 v13, v13
    v_mov_b32 v11, v7
    v_fma_f32 v60, v60, s36, -v11
    v_exp_f32 v60, v60
    v_fma_f32 v61, v61, s36, -v11
    v_exp_f32 v61, v61
    v_fma_f32 v62, v62, s36, -v11
    v_exp_f32 v62, v62
    v_fma_f32 v63, v63, s36, -v11
    v_exp_f32 v63, v63
    v_fma_f32 v64, v64, s36, -v11
    v_exp_f32 v64, v64
    v_fma_f32 v65, v65, s36, -v11
    v_exp_f32 v65, v65
    v_fma_f32 v66, v66, s36, -v11
    v_exp_f32 v66, v66
    v_fma_f32 v67, v67, s36, -v11
    v_exp_f32 v67, v67
    v_fma_f32 v68, v68, s36, -v11
    v_exp_f32 v68, v68
    v_fma_f32 v69, v69, s36, -v11
    v_exp_f32 v69, v69
    v_fma_f32 v70, v70, s36, -v11
    v_exp_f32 v70, v70
    v_fma_f32 v71, v71, s36, -v11
    v_exp_f32 v71, v71
    v_fma_f32 v72, v72, s36, -v11
    v_exp_f32 v72, v72
    v_fma_f32 v73, v73, s36, -v11
    v_exp_f32 v73, v73
    v_fma_f32 v74, v74, s36, -v11
    v_exp_f32 v74, v74
    v_fma_f32 v75, v75, s36, -v11
    v_exp_f32 v75, v75
    v_mul_f32 v12, v12, v13
    v_add_f32 v12, v12, v60
    v_add_f32 v12, v12, v61
    v_add_f32 v12, v12, v62
    v_add_f32 v12, v12, v63
    v_add_f32 v12, v12, v64
    v_add_f32 v12, v12, v65
    v_add_f32 v12, v12, v66
    v_add_f32 v12, v12, v67
    v_add_f32 v12, v12, v68
    v_add_f32 v12, v12, v69
    v_add_f32 v12, v12, v70
    v_add_f32 v12, v12, v71
    v_add_f32 v12, v12, v72
    v_add_f32 v12, v12, v73
    v_add_f32 v12, v12, v74
    v_add_f32 v12, v12, v75
    v_cvt_pk_bf16_f32 v76, v60, v61
    v_cvt_pk_bf16_f32 v77, v62, v63
    v_cvt_pk_bf16_f32 v78, v64, v65
    v_cvt_pk_bf16_f32 v79, v66, v67
    v_cvt_pk_bf16_f32 v80, v68, v69
    v_cvt_pk_bf16_f32 v81, v70, v71
    v_cvt_pk_bf16_f32 v82, v72, v73
    v_cvt_pk_bf16_f32 v83, v74, v75
    v_mul_f32 v148, v13, v148
    v_mul_f32 v149, v13, v149
    v_mul_f32 v150, v13, v150
    v_mul_f32 v151, v13, v151
    v_mul_f32 v152, v13, v152
    v_mul_f32 v153, v13, v153
    v_mul_f32 v154, v13, v154
    v_mul_f32 v155, v13, v155
    v_mul_f32 v156, v13, v156
    v_mul_f32 v157, v13, v157
    v_mul_f32 v158, v13, v158
    v_mul_f32 v159, v13, v159
    v_mul_f32 v160, v13, v160
    v_mul_f32 v161, v13, v161
    v_mul_f32 v162, v13, v162
    v_mul_f32 v163, v13, v163
    v_mul_f32 v164, v13, v164
    v_mul_f32 v165, v13, v165
    v_mul_f32 v166, v13, v166
    v_mul_f32 v167, v13, v167
    v_mul_f32 v168, v13, v168
    v_mul_f32 v169, v13, v169
    v_mul_f32 v170, v13, v170
    v_mul_f32 v171, v13, v171
    v_mul_f32 v172, v13, v172
    v_mul_f32 v173, v13, v173
    v_mul_f32 v174, v13, v174
    v_mul_f32 v175, v13, v175
    v_mul_f32 v176, v13, v176
    v_mul_f32 v177, v13, v177
    v_mul_f32 v178, v13, v178
    v_mul_f32 v179, v13, v179
    v_mul_f32 v180, v13, v180
    v_mul_f32 v181, v13, v181
    v_mul_f32 v182, v13, v182
    v_mul_f32 v183, v13, v183
    v_mul_f32 v184, v13, v184
    v_mul_f32 v185, v13, v185
    v_mul_f32 v186, v13, v186
    v_mul_f32 v187, v13, v187
    v_mul_f32 v188, v13, v188
    v_mul_f32 v189, v13, v189
    v_mul_f32 v190, v13, v190
    v_mul_f32 v191, v13, v191
    v_mul_f32 v192, v13, v192
    v_mul_f32 v193, v13, v193
    v_mul_f32 v194, v13, v194
    v_mul_f32 v195, v13, v195
    v_mul_f32 v196, v13, v196
    v_mul_f32 v197, v13, v197
    v_mul_f32 v198, v13, v198
    v_mul_f32 v199, v13, v199
    v_mul_f32 v200, v13, v200
    v_mul_f32 v201, v13, v201
    v_mul_f32 v202, v13, v202
    v_mul_f32 v203, v13, v203
    v_mul_f32 v204, v13, v204
    v_mul_f32 v205, v13, v205
    v_mul_f32 v206, v13, v206
    v_mul_f32 v207, v13, v207
    v_mul_f32 v208, v13, v208
    v_mul_f32 v209, v13, v209
    v_mul_f32 v210, v13, v210
    v_mul_f32 v211, v13, v211
    s_waitcnt lgkmcnt(0)
    v_mfma_f32_32x32x16_bf16 v[148:163], v[116:119], v[76:79], v[148:163]
    v_mfma_f32_32x32x16_bf16 v[164:179], v[120:123], v[76:79], v[164:179]
    v_mfma_f32_32x32x16_bf16 v[180:195], v[124:127], v[76:79], v[180:195]
    v_mfma_f32_32x32x16_bf16 v[196:211], v[128:131], v[76:79], v[196:211]
    v_mfma_f32_32x32x16_bf16 v[148:163], v[132:135], v[80:83], v[148:163]
    v_mfma_f32_32x32x16_bf16 v[164:179], v[136:139], v[80:83], v[164:179]
    v_mfma_f32_32x32x16_bf16 v[180:195], v[140:143], v[80:83], v[180:195]
    v_mfma_f32_32x32x16_bf16 v[196:211], v[144:147], v[80:83], v[196:211]
    s_waitcnt vmcnt(8)
    s_barrier
    ds_read_b128 v[84:87], v16 offset:32768
    ds_read_b128 v[88:91], v17 offset:32768
    ds_read_b128 v[92:95], v18 offset:32768
    ds_read_b128 v[96:99], v19 offset:32768
    ds_read_b128 v[100:103], v20 offset:32768
    ds_read_b128 v[104:107], v21 offset:32768
    ds_read_b128 v[108:111], v22 offset:32768
    ds_read_b128 v[112:115], v23 offset:32768
    s_waitcnt lgkmcnt(7)
    v_mfma_f32_32x32x16_bf16 v[60:75], v[84:87], v[28:31], 0
    s_waitcnt lgkmcnt(6)
    v_mfma_f32_32x32x16_bf16 v[60:75], v[88:91], v[32:35], v[60:75]
    s_waitcnt lgkmcnt(5)
    v_mfma_f32_32x32x16_bf16 v[60:75], v[92:95], v[36:39], v[60:75]
    s_waitcnt lgkmcnt(4)
    v_mfma_f32_32x32x16_bf16 v[60:75], v[96:99], v[40:43], v[60:75]
    s_waitcnt lgkmcnt(3)
    v_mfma_f32_32x32x16_bf16 v[60:75], v[100:103], v[44:47], v[60:75]
    s_waitcnt lgkmcnt(2)
    v_mfma_f32_32x32x16_bf16 v[60:75], v[104:107], v[48:51], v[60:75]
    s_waitcnt lgkmcnt(1)
    v_mfma_f32_32x32x16_bf16 v[60:75], v[108:111], v[52:55], v[60:75]
    s_waitcnt lgkmcnt(0)
    v_mfma_f32_32x32x16_bf16 v[60:75], v[112:115], v[56:59], v[60:75]
    ds_read_b64_tr_b16 v[116:117], v24 offset:49152
    ds_read_b64_tr_b16 v[118:119], v24 offset:51200
    ds_read_b64_tr_b16 v[120:121], v25 offset:49152
    ds_read_b64_tr_b16 v[122:123], v25 offset:51200
    ds_read_b64_tr_b16 v[124:125], v26 offset:49152
    ds_read_b64_tr_b16 v[126:127], v26 offset:51200
    ds_read_b64_tr_b16 v[128:129], v27 offset:49152
    ds_read_b64_tr_b16 v[130:131], v27 offset:51200
    ds_read_b64_tr_b16 v[132:133], v24 offset:53248
    ds_read_b64_tr_b16 v[134:135], v24 offset:55296
    ds_read_b64_tr_b16 v[136:137], v25 offset:53248
    ds_read_b64_tr_b16 v[138:139], v25 offset:55296
    ds_read_b64_tr_b16 v[140:141], v26 offset:53248
    ds_read_b64_tr_b16 v[142:143], v26 offset:55296
    ds_read_b64_tr_b16 v[144:145], v27 offset:53248
    ds_read_b64_tr_b16 v[146:147], v27 offset:55296
    s_nop 7
    s_nop 3
    v_max3_f32 v7, v60, v61, v62
    v_max3_f32 v7, v7, v63, v64
    v_max3_f32 v7, v7, v65, v66
    v_max3_f32 v7, v7, v67, v68
    v_max3_f32 v7, v7, v69, v70
    v_max3_f32 v7, v7, v71, v72
    v_max3_f32 v7, v7, v73, v74
    v_max_f32 v7, v7, v75
    v_mov_b32 v8, v7
    s_nop 1
    v_permlane32_swap_b32 v7, v8
    v_max_f32 v7, v7, v8
    v_mul_f32 v7, s36, v7
    v_max_f32 v7, v7, v11
    v_sub_f32 v13, v11, v7
    v_exp_f32 v13, v13
    v_mov_b32 v11, v7
    v_fma_f32 v60, v60, s36, -v11
    v_exp_f32 v60, v60
    v_fma_f32 v61, v61, s36, -v11
    v_exp_f32 v61, v61
    v_fma_f32 v62, v62, s36, -v11
    v_exp_f32 v62, v62
    v_fma_f32 v63, v63, s36, -v11
    v_exp_f32 v63, v63
    v_fma_f32 v64, v64, s36, -v11
    v_exp_f32 v64, v64
    v_fma_f32 v65, v65, s36, -v11
    v_exp_f32 v65, v65
    v_fma_f32 v66, v66, s36, -v11
    v_exp_f32 v66, v66
    v_fma_f32 v67, v67, s36, -v11
    v_exp_f32 v67, v67
    v_fma_f32 v68, v68, s36, -v11
    v_exp_f32 v68, v68
    v_fma_f32 v69, v69, s36, -v11
    v_exp_f32 v69, v69
    v_fma_f32 v70, v70, s36, -v11
    v_exp_f32 v70, v70
    v_fma_f32 v71, v71, s36, -v11
    v_exp_f32 v71, v71
    v_fma_f32 v72, v72, s36, -v11
    v_exp_f32 v72, v72
    v_fma_f32 v73, v73, s36, -v11
    v_exp_f32 v73, v73
    v_fma_f32 v74, v74, s36, -v11
    v_exp_f32 v74, v74
    v_fma_f32 v75, v75, s36, -v11
    v_exp_f32 v75, v75
    v_mul_f32 v12, v12, v13
    v_add_f32 v12, v12, v60
    v_add_f32 v12, v12, v61
    v_add_f32 v12, v12, v62
    v_add_f32 v12, v12, v63
    v_add_f32 v12, v12, v64
    v_add_f32 v12, v12, v65
    v_add_f32 v12, v12, v66
    v_add_f32 v12, v12, v67
    v_add_f32 v12, v12, v68
    v_add_f32 v12, v12, v69
    v_add_f32 v12, v12, v70
    v_add_f32 v12, v12, v71
    v_add_f32 v12, v12, v72
    v_add_f32 v12, v12, v73
    v_add_f32 v12, v12, v74
    v_add_f32 v12, v12, v75
    v_cvt_pk_bf16_f32 v76, v60, v61
    v_cvt_pk_bf16_f32 v77, v62, v63
    v_cvt_pk_bf16_f32 v78, v64, v65
    v_cvt_pk_bf16_f32 v79, v66, v67
    v_cvt_pk_bf16_f32 v80, v68, v69
    v_cvt_pk_bf16_f32 v81, v70, v71
    v_cvt_pk_bf16_f32 v82, v72, v73
    v_cvt_pk_bf16_f32 v83, v74, v75
    v_mul_f32 v148, v13, v148
    v_mul_f32 v149, v13, v149
    v_mul_f32 v150, v13, v150
    v_mul_f32 v151, v13, v151
    v_mul_f32 v152, v13, v152
    v_mul_f32 v153, v13, v153
    v_mul_f32 v154, v13, v154
    v_mul_f32 v155, v13, v155
    v_mul_f32 v156, v13, v156
    v_mul_f32 v157, v13, v157
    v_mul_f32 v158, v13, v158
    v_mul_f32 v159, v13, v159
    v_mul_f32 v160, v13, v160
    v_mul_f32 v161, v13, v161
    v_mul_f32 v162, v13, v162
    v_mul_f32 v163, v13, v163
    v_mul_f32 v164, v13, v164
    v_mul_f32 v165, v13, v165
    v_mul_f32 v166, v13, v166
    v_mul_f32 v167, v13, v167
    v_mul_f32 v168, v13, v168
    v_mul_f32 v169, v13, v169
    v_mul_f32 v170, v13, v170
    v_mul_f32 v171, v13, v171
    v_mul_f32 v172, v13, v172
    v_mul_f32 v173, v13, v173
    v_mul_f32 v174, v13, v174
    v_mul_f32 v175, v13, v175
    v_mul_f32 v176, v13, v176
    v_mul_f32 v177, v13, v177
    v_mul_f32 v178, v13, v178
    v_mul_f32 v179, v13, v179
    v_mul_f32 v180, v13, v180
    v_mul_f32 v181, v13, v181
    v_mul_f32 v182, v13, v182
    v_mul_f32 v183, v13, v183
    v_mul_f32 v184, v13, v184
    v_mul_f32 v185, v13, v185
    v_mul_f32 v186, v13, v186
    v_mul_f32 v187, v13, v187
    v_mul_f32 v188, v13, v188
    v_mul_f32 v189, v13, v189
    v_mul_f32 v190, v13, v190
    v_mul_f32 v191, v13, v191
    v_mul_f32 v192, v13, v192
    v_mul_f32 v193, v13, v193
    v_mul_f32 v194, v13, v194
    v_mul_f32 v195, v13, v195
    v_mul_f32 v196, v13, v196
    v_mul_f32 v197, v13, v197
    v_mul_f32 v198, v13, v198
    v_mul_f32 v199, v13, v199
    v_mul_f32 v200, v13, v200
    v_mul_f32 v201, v13, v201
    v_mul_f32 v202, v13, v202
    v_mul_f32 v203, v13, v203
    v_mul_f32 v204, v13, v204
    v_mul_f32 v205, v13, v205
    v_mul_f32 v206, v13, v206
    v_mul_f32 v207, v13, v207
    v_mul_f32 v208, v13, v208
    v_mul_f32 v209, v13, v209
    v_mul_f32 v210, v13, v210
    v_mul_f32 v211, v13, v211
    s_waitcnt lgkmcnt(0)
    v_mfma_f32_32x32x16_bf16 v[148:163], v[116:119], v[76:79], v[148:163]
    v_mfma_f32_32x32x16_bf16 v[164:179], v[120:123], v[76:79], v[164:179]
    v_mfma_f32_32x32x16_bf16 v[180:195], v[124:127], v[76:79], v[180:195]
    v_mfma_f32_32x32x16_bf16 v[196:211], v[128:131], v[76:79], v[196:211]
    v_mfma_f32_32x32x16_bf16 v[148:163], v[132:135], v[80:83], v[148:163]
    v_mfma_f32_32x32x16_bf16 v[164:179], v[136:139], v[80:83], v[164:179]
    v_mfma_f32_32x32x16_bf16 v[180:195], v[140:143], v[80:83], v[180:195]
    v_mfma_f32_32x32x16_bf16 v[196:211], v[144:147], v[80:83], v[196:211]
    s_waitcnt vmcnt(4)
    s_barrier
    v_add_u32 v16, 0x10000, v16
    v_add_u32 v17, 0x10000, v17
    v_add_u32 v18, 0x10000, v18
    v_add_u32 v19, 0x10000, v19
    v_add_u32 v20, 0x10000, v20
    v_add_u32 v21, 0x10000, v21
    v_add_u32 v22, 0x10000, v22
    v_add_u32 v23, 0x10000, v23
    v_add_u32 v24, 0x10000, v24
    v_add_u32 v25, 0x10000, v25
    v_add_u32 v26, 0x10000, v26
    v_add_u32 v27, 0x10000, v27
    ds_read_b128 v[84:87], v16 offset:0
    ds_read_b128 v[88:91], v17 offset:0
    ds_read_b128 v[92:95], v18 offset:0
    ds_read_b128 v[96:99], v19 offset:0
    ds_read_b128 v[100:103], v20 offset:0
    ds_read_b128 v[104:107], v21 offset:0
    ds_read_b128 v[108:111], v22 offset:0
    ds_read_b128 v[112:115], v23 offset:0
    s_waitcnt lgkmcnt(7)
    v_mfma_f32_32x32x16_bf16 v[60:75], v[84:87], v[28:31], 0
    s_waitcnt lgkmcnt(6)
    v_mfma_f32_32x32x16_bf16 v[60:75], v[88:91], v[32:35], v[60:75]
    s_waitcnt lgkmcnt(5)
    v_mfma_f32_32x32x16_bf16 v[60:75], v[92:95], v[36:39], v[60:75]
    s_waitcnt lgkmcnt(4)
    v_mfma_f32_32x32x16_bf16 v[60:75], v[96:99], v[40:43], v[60:75]
    s_waitcnt lgkmcnt(3)
    v_mfma_f32_32x32x16_bf16 v[60:75], v[100:103], v[44:47], v[60:75]
    s_waitcnt lgkmcnt(2)
    v_mfma_f32_32x32x16_bf16 v[60:75], v[104:107], v[48:51], v[60:75]
    s_waitcnt lgkmcnt(1)
    v_mfma_f32_32x32x16_bf16 v[60:75], v[108:111], v[52:55], v[60:75]
    s_waitcnt lgkmcnt(0)
    v_mfma_f32_32x32x16_bf16 v[60:75], v[112:115], v[56:59], v[60:75]
    ds_read_b64_tr_b16 v[116:117], v24 offset:16384
    ds_read_b64_tr_b16 v[118:119], v24 offset:18432
    ds_read_b64_tr_b16 v[120:121], v25 offset:16384
    ds_read_b64_tr_b16 v[122:123], v25 offset:18432
    ds_read_b64_tr_b16 v[124:125], v26 offset:16384
    ds_read_b64_tr_b16 v[126:127], v26 offset:18432
    ds_read_b64_tr_b16 v[128:129], v27 offset:16384
    ds_read_b64_tr_b16 v[130:131], v27 offset:18432
    ds_read_b64_tr_b16 v[132:133], v24 offset:20480
    ds_read_b64_tr_b16 v[134:135], v24 offset:22528
    ds_read_b64_tr_b16 v[136:137], v25 offset:20480
    ds_read_b64_tr_b16 v[138:139], v25 offset:22528
    ds_read_b64_tr_b16 v[140:141], v26 offset:20480
    ds_read_b64_tr_b16 v[142:143], v26 offset:22528
    ds_read_b64_tr_b16 v[144:145], v27 offset:20480
    ds_read_b64_tr_b16 v[146:147], v27 offset:22528
    s_nop 7
    s_nop 3
    v_max3_f32 v7, v60, v61, v62
    v_max3_f32 v7, v7, v63, v64
    v_max3_f32 v7, v7, v65, v66
    v_max3_f32 v7, v7, v67, v68
    v_max3_f32 v7, v7, v69, v70
    v_max3_f32 v7, v7, v71, v72
    v_max3_f32 v7, v7, v73, v74
    v_max_f32 v7, v7, v75
    v_mov_b32 v8, v7
    s_nop 1
    v_permlane32_swap_b32 v7, v8
    v_max_f32 v7, v7, v8
    v_mul_f32 v7, s36, v7
    v_max_f32 v7, v7, v11
    v_sub_f32 v13, v11, v7
    v_exp_f32 v13, v13
    v_mov_b32 v11, v7
    v_fma_f32 v60, v60, s36, -v11
    v_exp_f32 v60, v60
    v_fma_f32 v61, v61, s36, -v11
    v_exp_f32 v61, v61
    v_fma_f32 v62, v62, s36, -v11
    v_exp_f32 v62, v62
    v_fma_f32 v63, v63, s36, -v11
    v_exp_f32 v63, v63
    v_fma_f32 v64, v64, s36, -v11
    v_exp_f32 v64, v64
    v_fma_f32 v65, v65, s36, -v11
    v_exp_f32 v65, v65
    v_fma_f32 v66, v66, s36, -v11
    v_exp_f32 v66, v66
    v_fma_f32 v67, v67, s36, -v11
    v_exp_f32 v67, v67
    v_fma_f32 v68, v68, s36, -v11
    v_exp_f32 v68, v68
    v_fma_f32 v69, v69, s36, -v11
    v_exp_f32 v69, v69
    v_fma_f32 v70, v70, s36, -v11
    v_exp_f32 v70, v70
    v_fma_f32 v71, v71, s36, -v11
    v_exp_f32 v71, v71
    v_fma_f32 v72, v72, s36, -v11
    v_exp_f32 v72, v72
    v_fma_f32 v73, v73, s36, -v11
    v_exp_f32 v73, v73
    v_fma_f32 v74, v74, s36, -v11
    v_exp_f32 v74, v74
    v_fma_f32 v75, v75, s36, -v11
    v_exp_f32 v75, v75
    v_mul_f32 v12, v12, v13
    v_add_f32 v12, v12, v60
    v_add_f32 v12, v12, v61
    v_add_f32 v12, v12, v62
    v_add_f32 v12, v12, v63
    v_add_f32 v12, v12, v64
    v_add_f32 v12, v12, v65
    v_add_f32 v12, v12, v66
    v_add_f32 v12, v12, v67
    v_add_f32 v12, v12, v68
    v_add_f32 v12, v12, v69
    v_add_f32 v12, v12, v70
    v_add_f32 v12, v12, v71
    v_add_f32 v12, v12, v72
    v_add_f32 v12, v12, v73
    v_add_f32 v12, v12, v74
    v_add_f32 v12, v12, v75
    v_cvt_pk_bf16_f32 v76, v60, v61
    v_cvt_pk_bf16_f32 v77, v62, v63
    v_cvt_pk_bf16_f32 v78, v64, v65
    v_cvt_pk_bf16_f32 v79, v66, v67
    v_cvt_pk_bf16_f32 v80, v68, v69
    v_cvt_pk_bf16_f32 v81, v70, v71
    v_cvt_pk_bf16_f32 v82, v72, v73
    v_cvt_pk_bf16_f32 v83, v74, v75
    v_mul_f32 v148, v13, v148
    v_mul_f32 v149, v13, v149
    v_mul_f32 v150, v13, v150
    v_mul_f32 v151, v13, v151
    v_mul_f32 v152, v13, v152
    v_mul_f32 v153, v13, v153
    v_mul_f32 v154, v13, v154
    v_mul_f32 v155, v13, v155
    v_mul_f32 v156, v13, v156
    v_mul_f32 v157, v13, v157
    v_mul_f32 v158, v13, v158
    v_mul_f32 v159, v13, v159
    v_mul_f32 v160, v13, v160
    v_mul_f32 v161, v13, v161
    v_mul_f32 v162, v13, v162
    v_mul_f32 v163, v13, v163
    v_mul_f32 v164, v13, v164
    v_mul_f32 v165, v13, v165
    v_mul_f32 v166, v13, v166
    v_mul_f32 v167, v13, v167
    v_mul_f32 v168, v13, v168
    v_mul_f32 v169, v13, v169
    v_mul_f32 v170, v13, v170
    v_mul_f32 v171, v13, v171
    v_mul_f32 v172, v13, v172
    v_mul_f32 v173, v13, v173
    v_mul_f32 v174, v13, v174
    v_mul_f32 v175, v13, v175
    v_mul_f32 v176, v13, v176
    v_mul_f32 v177, v13, v177
    v_mul_f32 v178, v13, v178
    v_mul_f32 v179, v13, v179
    v_mul_f32 v180, v13, v180
    v_mul_f32 v181, v13, v181
    v_mul_f32 v182, v13, v182
    v_mul_f32 v183, v13, v183
    v_mul_f32 v184, v13, v184
    v_mul_f32 v185, v13, v185
    v_mul_f32 v186, v13, v186
    v_mul_f32 v187, v13, v187
    v_mul_f32 v188, v13, v188
    v_mul_f32 v189, v13, v189
    v_mul_f32 v190, v13, v190
    v_mul_f32 v191, v13, v191
    v_mul_f32 v192, v13, v192
    v_mul_f32 v193, v13, v193
    v_mul_f32 v194, v13, v194
    v_mul_f32 v195, v13, v195
    v_mul_f32 v196, v13, v196
    v_mul_f32 v197, v13, v197
    v_mul_f32 v198, v13, v198
    v_mul_f32 v199, v13, v199
    v_mul_f32 v200, v13, v200
    v_mul_f32 v201, v13, v201
    v_mul_f32 v202, v13, v202
    v_mul_f32 v203, v13, v203
    v_mul_f32 v204, v13, v204
    v_mul_f32 v205, v13, v205
    v_mul_f32 v206, v13, v206
    v_mul_f32 v207, v13, v207
    v_mul_f32 v208, v13, v208
    v_mul_f32 v209, v13, v209
    v_mul_f32 v210, v13, v210
    v_mul_f32 v211, v13, v211
    s_waitcnt lgkmcnt(0)
    v_mfma_f32_32x32x16_bf16 v[148:163], v[116:119], v[76:79], v[148:163]
    v_mfma_f32_32x32x16_bf16 v[164:179], v[120:123], v[76:79], v[164:179]
    v_mfma_f32_32x32x16_bf16 v[180:195], v[124:127], v[76:79], v[180:195]
    v_mfma_f32_32x32x16_bf16 v[196:211], v[128:131], v[76:79], v[196:211]
    v_mfma_f32_32x32x16_bf16 v[148:163], v[132:135], v[80:83], v[148:163]
    v_mfma_f32_32x32x16_bf16 v[164:179], v[136:139], v[80:83], v[164:179]
    v_mfma_f32_32x32x16_bf16 v[180:195], v[140:143], v[80:83], v[180:195]
    v_mfma_f32_32x32x16_bf16 v[196:211], v[144:147], v[80:83], v[196:211]
    s_waitcnt vmcnt(0)
    s_barrier
    ds_read_b128 v[84:87], v16 offset:32768
    ds_read_b128 v[88:91], v17 offset:32768
    ds_read_b128 v[92:95], v18 offset:32768
    ds_read_b128 v[96:99], v19 offset:32768
    ds_read_b128 v[100:103], v20 offset:32768
    ds_read_b128 v[104:107], v21 offset:32768
    ds_read_b128 v[108:111], v22 offset:32768
    ds_read_b128 v[112:115], v23 offset:32768
    s_waitcnt lgkmcnt(7)
    v_mfma_f32_32x32x16_bf16 v[60:75], v[84:87], v[28:31], 0
    s_waitcnt lgkmcnt(6)
    v_mfma_f32_32x32x16_bf16 v[60:75], v[88:91], v[32:35], v[60:75]
    s_waitcnt lgkmcnt(5)
    v_mfma_f32_32x32x16_bf16 v[60:75], v[92:95], v[36:39], v[60:75]
    s_waitcnt lgkmcnt(4)
    v_mfma_f32_32x32x16_bf16 v[60:75], v[96:99], v[40:43], v[60:75]
    s_waitcnt lgkmcnt(3)
    v_mfma_f32_32x32x16_bf16 v[60:75], v[100:103], v[44:47], v[60:75]
    s_waitcnt lgkmcnt(2)
    v_mfma_f32_32x32x16_bf16 v[60:75], v[104:107], v[48:51], v[60:75]
    s_waitcnt lgkmcnt(1)
    v_mfma_f32_32x32x16_bf16 v[60:75], v[108:111], v[52:55], v[60:75]
    s_waitcnt lgkmcnt(0)
    v_mfma_f32_32x32x16_bf16 v[60:75], v[112:115], v[56:59], v[60:75]
    ds_read_b64_tr_b16 v[116:117], v24 offset:49152
    ds_read_b64_tr_b16 v[118:119], v24 offset:51200
    ds_read_b64_tr_b16 v[120:121], v25 offset:49152
    ds_read_b64_tr_b16 v[122:123], v25 offset:51200
    ds_read_b64_tr_b16 v[124:125], v26 offset:49152
    ds_read_b64_tr_b16 v[126:127], v26 offset:51200
    ds_read_b64_tr_b16 v[128:129], v27 offset:49152
    ds_read_b64_tr_b16 v[130:131], v27 offset:51200
    ds_read_b64_tr_b16 v[132:133], v24 offset:53248
    ds_read_b64_tr_b16 v[134:135], v24 offset:55296
    ds_read_b64_tr_b16 v[136:137], v25 offset:53248
    ds_read_b64_tr_b16 v[138:139], v25 offset:55296
    ds_read_b64_tr_b16 v[140:141], v26 offset:53248
    ds_read_b64_tr_b16 v[142:143], v26 offset:55296
    ds_read_b64_tr_b16 v[144:145], v27 offset:53248
    ds_read_b64_tr_b16 v[146:147], v27 offset:55296
    s_nop 7
    s_nop 3
    v_max3_f32 v7, v60, v61, v62
    v_max3_f32 v7, v7, v63, v64
    v_max3_f32 v7, v7, v65, v66
    v_max3_f32 v7, v7, v67, v68
    v_max3_f32 v7, v7, v69, v70
    v_max3_f32 v7, v7, v71, v72
    v_max3_f32 v7, v7, v73, v74
    v_max_f32 v7, v7, v75
    v_mov_b32 v8, v7
    s_nop 1
    v_permlane32_swap_b32 v7, v8
    v_max_f32 v7, v7, v8
    v_mul_f32 v7, s36, v7
    v_max_f32 v7, v7, v11
    v_sub_f32 v13, v11, v7
    v_exp_f32 v13, v13
    v_mov_b32 v11, v7
    v_fma_f32 v60, v60, s36, -v11
    v_exp_f32 v60, v60
    v_fma_f32 v61, v61, s36, -v11
    v_exp_f32 v61, v61
    v_fma_f32 v62, v62, s36, -v11
    v_exp_f32 v62, v62
    v_fma_f32 v63, v63, s36, -v11
    v_exp_f32 v63, v63
    v_fma_f32 v64, v64, s36, -v11
    v_exp_f32 v64, v64
    v_fma_f32 v65, v65, s36, -v11
    v_exp_f32 v65, v65
    v_fma_f32 v66, v66, s36, -v11
    v_exp_f32 v66, v66
    v_fma_f32 v67, v67, s36, -v11
    v_exp_f32 v67, v67
    v_fma_f32 v68, v68, s36, -v11
    v_exp_f32 v68, v68
    v_fma_f32 v69, v69, s36, -v11
    v_exp_f32 v69, v69
    v_fma_f32 v70, v70, s36, -v11
    v_exp_f32 v70, v70
    v_fma_f32 v71, v71, s36, -v11
    v_exp_f32 v71, v71
    v_fma_f32 v72, v72, s36, -v11
    v_exp_f32 v72, v72
    v_fma_f32 v73, v73, s36, -v11
    v_exp_f32 v73, v73
    v_fma_f32 v74, v74, s36, -v11
    v_exp_f32 v74, v74
    v_fma_f32 v75, v75, s36, -v11
    v_exp_f32 v75, v75
    v_mul_f32 v12, v12, v13
    v_add_f32 v12, v12, v60
    v_add_f32 v12, v12, v61
    v_add_f32 v12, v12, v62
    v_add_f32 v12, v12, v63
    v_add_f32 v12, v12, v64
    v_add_f32 v12, v12, v65
    v_add_f32 v12, v12, v66
    v_add_f32 v12, v12, v67
    v_add_f32 v12, v12, v68
    v_add_f32 v12, v12, v69
    v_add_f32 v12, v12, v70
    v_add_f32 v12, v12, v71
    v_add_f32 v12, v12, v72
    v_add_f32 v12, v12, v73
    v_add_f32 v12, v12, v74
    v_add_f32 v12, v12, v75
    v_cvt_pk_bf16_f32 v76, v60, v61
    v_cvt_pk_bf16_f32 v77, v62, v63
    v_cvt_pk_bf16_f32 v78, v64, v65
    v_cvt_pk_bf16_f32 v79, v66, v67
    v_cvt_pk_bf16_f32 v80, v68, v69
    v_cvt_pk_bf16_f32 v81, v70, v71
    v_cvt_pk_bf16_f32 v82, v72, v73
    v_cvt_pk_bf16_f32 v83, v74, v75
    v_mul_f32 v148, v13, v148
    v_mul_f32 v149, v13, v149
    v_mul_f32 v150, v13, v150
    v_mul_f32 v151, v13, v151
    v_mul_f32 v152, v13, v152
    v_mul_f32 v153, v13, v153
    v_mul_f32 v154, v13, v154
    v_mul_f32 v155, v13, v155
    v_mul_f32 v156, v13, v156
    v_mul_f32 v157, v13, v157
    v_mul_f32 v158, v13, v158
    v_mul_f32 v159, v13, v159
    v_mul_f32 v160, v13, v160
    v_mul_f32 v161, v13, v161
    v_mul_f32 v162, v13, v162
    v_mul_f32 v163, v13, v163
    v_mul_f32 v164, v13, v164
    v_mul_f32 v165, v13, v165
    v_mul_f32 v166, v13, v166
    v_mul_f32 v167, v13, v167
    v_mul_f32 v168, v13, v168
    v_mul_f32 v169, v13, v169
    v_mul_f32 v170, v13, v170
    v_mul_f32 v171, v13, v171
    v_mul_f32 v172, v13, v172
    v_mul_f32 v173, v13, v173
    v_mul_f32 v174, v13, v174
    v_mul_f32 v175, v13, v175
    v_mul_f32 v176, v13, v176
    v_mul_f32 v177, v13, v177
    v_mul_f32 v178, v13, v178
    v_mul_f32 v179, v13, v179
    v_mul_f32 v180, v13, v180
    v_mul_f32 v181, v13, v181
    v_mul_f32 v182, v13, v182
    v_mul_f32 v183, v13, v183
    v_mul_f32 v184, v13, v184
    v_mul_f32 v185, v13, v185
    v_mul_f32 v186, v13, v186
    v_mul_f32 v187, v13, v187
    v_mul_f32 v188, v13, v188
    v_mul_f32 v189, v13, v189
    v_mul_f32 v190, v13, v190
    v_mul_f32 v191, v13, v191
    v_mul_f32 v192, v13, v192
    v_mul_f32 v193, v13, v193
    v_mul_f32 v194, v13, v194
    v_mul_f32 v195, v13, v195
    v_mul_f32 v196, v13, v196
    v_mul_f32 v197, v13, v197
    v_mul_f32 v198, v13, v198
    v_mul_f32 v199, v13, v199
    v_mul_f32 v200, v13, v200
    v_mul_f32 v201, v13, v201
    v_mul_f32 v202, v13, v202
    v_mul_f32 v203, v13, v203
    v_mul_f32 v204, v13, v204
    v_mul_f32 v205, v13, v205
    v_mul_f32 v206, v13, v206
    v_mul_f32 v207, v13, v207
    v_mul_f32 v208, v13, v208
    v_mul_f32 v209, v13, v209
    v_mul_f32 v210, v13, v210
    v_mul_f32 v211, v13, v211
    s_waitcnt lgkmcnt(0)
    v_mfma_f32_32x32x16_bf16 v[148:163], v[116:119], v[76:79], v[148:163]
    v_mfma_f32_32x32x16_bf16 v[164:179], v[120:123], v[76:79], v[164:179]
    v_mfma_f32_32x32x16_bf16 v[180:195], v[124:127], v[76:79], v[180:195]
    v_mfma_f32_32x32x16_bf16 v[196:211], v[128:131], v[76:79], v[196:211]
    v_mfma_f32_32x32x16_bf16 v[148:163], v[132:135], v[80:83], v[148:163]
    v_mfma_f32_32x32x16_bf16 v[164:179], v[136:139], v[80:83], v[164:179]
    v_mfma_f32_32x32x16_bf16 v[180:195], v[140:143], v[80:83], v[180:195]
    v_mfma_f32_32x32x16_bf16 v[196:211], v[144:147], v[80:83], v[196:211]
    s_nop 7
    s_nop 7
    v_mov_b32 v7, v12
    v_mov_b32 v8, v12
    s_nop 1
    v_permlane32_swap_b32 v7, v8
    v_add_f32 v12, v7, v8
    s_barrier
    v_lshlrev_b32 v14, 2, v1
    s_mul_i32 s28, s33, 20480
    v_add_u32 v14, s28, v14
    s_cmp_eq_u32 s32, 0
    s_cbranch_scc1 L_merge_rd
    ds_write_b32 v14, v148 offset:0
    ds_write_b32 v14, v149 offset:256
    ds_write_b32 v14, v150 offset:512
    ds_write_b32 v14, v151 offset:768
    ds_write_b32 v14, v152 offset:1024
    ds_write_b32 v14, v153 offset:1280
    ds_write_b32 v14, v154 offset:1536
    ds_write_b32 v14, v155 offset:1792
    ds_write_b32 v14, v156 offset:2048
    ds_write_b32 v14, v157 offset:2304
    ds_write_b32 v14, v158 offset:2560
    ds_write_b32 v14, v159 offset:2816
    ds_write_b32 v14, v160 offset:3072
    ds_write_b32 v14, v161 offset:3328
    ds_write_b32 v14, v162 offset:3584
    ds_write_b32 v14, v163 offset:3840
    ds_write_b32 v14, v164 offset:4096
    ds_write_b32 v14, v165 offset:4352
    ds_write_b32 v14, v166 offset:4608
    ds_write_b32 v14, v167 offset:4864
    ds_write_b32 v14, v168 offset:5120
    ds_write_b32 v14, v169 offset:5376
    ds_write_b32 v14, v170 offset:5632
    ds_write_b32 v14, v171 offset:5888
    ds_write_b32 v14, v172 offset:6144
    ds_write_b32 v14, v173 offset:6400
    ds_write_b32 v14, v174 offset:6656
    ds_write_b32 v14, v175 offset:6912
    ds_write_b32 v14, v176 offset:7168
    ds_write_b32 v14, v177 offset:7424
    ds_write_b32 v14, v178 offset:7680
    ds_write_b32 v14, v179 offset:7936
    ds_write_b32 v14, v180 offset:8192
    ds_write_b32 v14, v181 offset:8448
    ds_write_b32 v14, v182 offset:8704
    ds_write_b32 v14, v183 offset:8960
    ds_write_b32 v14, v184 offset:9216
    ds_write_b32 v14, v185 offset:9472
    ds_write_b32 v14, v186 offset:9728
    ds_write_b32 v14, v187 offset:9984
    ds_write_b32 v14, v188 offset:10240
    ds_write_b32 v14, v189 offset:10496
    ds_write_b32 v14, v190 offset:10752
    ds_write_b32 v14, v191 offset:11008
    ds_write_b32 v14, v192 offset:11264
    ds_write_b32 v14, v193 offset:11520
    ds_write_b32 v14, v194 offset:11776
    ds_write_b32 v14, v195 offset:12032
    ds_write_b32 v14, v196 offset:12288
    ds_write_b32 v14, v197 offset:12544
    ds_write_b32 v14, v198 offset:12800
    ds_write_b32 v14, v199 offset:13056
    ds_write_b32 v14, v200 offset:13312
    ds_write_b32 v14, v201 offset:13568
    ds_write_b32 v14, v202 offset:13824
    ds_write_b32 v14, v203 offset:14080
    ds_write_b32 v14, v204 offset:14336
    ds_write_b32 v14, v205 offset:14592
    ds_write_b32 v14, v206 offset:14848
    ds_write_b32 v14, v207 offset:15104
    ds_write_b32 v14, v208 offset:15360
    ds_write_b32 v14, v209 offset:15616
    ds_write_b32 v14, v210 offset:15872
    ds_write_b32 v14, v211 offset:16128
    ds_write_b32 v14, v11 offset:16384
    ds_write_b32 v14, v12 offset:16640
    s_waitcnt lgkmcnt(0)
    s_barrier
    s_branch L_attn_end
L_merge_rd:
    s_barrier
    ds_read_b32 v7, v14 offset:16384
    ds_read_b32 v8, v14 offset:16640
    s_waitcnt lgkmcnt(0)
    ds_read_b32 v84, v14 offset:0
    ds_read_b32 v85, v14 offset:256
    ds_read_b32 v86, v14 offset:512
    ds_read_b32 v87, v14 offset:768
    ds_read_b32 v88, v14 offset:1024
    ds_read_b32 v89, v14 offset:1280
    ds_read_b32 v90, v14 offset:1536
    ds_read_b32 v91, v14 offset:1792
    ds_read_b32 v92, v14 offset:2048
    ds_read_b32 v93, v14 offset:2304
    ds_read_b32 v94, v14 offset:2560
    ds_read_b32 v95, v14 offset:2816
    ds_read_b32 v96, v14 offset:3072
    ds_read_b32 v97, v14 offset:3328
    ds_read_b32 v98, v14 offset:3584
    ds_read_b32 v99, v14 offset:3840
    ds_read_b32 v100, v14 offset:4096
    ds_read_b32 v101, v14 offset:4352
    ds_read_b32 v102, v14 offset:4608
    ds_read_b32 v103, v14 offset:4864
    ds_read_b32 v104, v14 offset:5120
    ds_read_b32 v105, v14 offset:5376
    ds_read_b32 v106, v14 offset:5632
    ds_read_b32 v107, v14 offset:5888
    ds_read_b32 v108, v14 offset:6144
    ds_read_b32 v109, v14 offset:6400
    ds_read_b32 v110, v14 offset:6656
    ds_read_b32 v111, v14 offset:6912
    ds_read_b32 v112, v14 offset:7168
    ds_read_b32 v113, v14 offset:7424
    ds_read_b32 v114, v14 offset:7680
    ds_read_b32 v115, v14 offset:7936
    v_max_f32 v15, v11, v7
    v_sub_f32 v11, v11, v15
    v_sub_f32 v7, v7, v15
    v_exp_f32 v11, v11
    v_exp_f32 v7, v7
    s_nop 0
    v_mul_f32 v12, v12, v11
    v_fma_f32 v12, v8, v7, v12
    v_rcp_f32 v12, v12
    s_nop 0
    v_mul_f32 v11, v11, v12
    v_mul_f32 v7, v7, v12
    s_waitcnt lgkmcnt(0)
    v_mul_f32 v148, v148, v11
    v_fma_f32 v148, v84, v7, v148
    v_mul_f32 v149, v149, v11
    v_fma_f32 v149, v85, v7, v149
    v_mul_f32 v150, v150, v11
    v_fma_f32 v150, v86, v7, v150
    v_mul_f32 v151, v151, v11
    v_fma_f32 v151, v87, v7, v151
    v_mul_f32 v152, v152, v11
    v_fma_f32 v152, v88, v7, v152
    v_mul_f32 v153, v153, v11
    v_fma_f32 v153, v89, v7, v153
    v_mul_f32 v154, v154, v11
    v_fma_f32 v154, v90, v7, v154
    v_mul_f32 v155, v155, v11
    v_fma_f32 v155, v91, v7, v155
    v_mul_f32 v156, v156, v11
    v_fma_f32 v156, v92, v7, v156
    v_mul_f32 v157, v157, v11
    v_fma_f32 v157, v93, v7, v157
    v_mul_f32 v158, v158, v11
    v_fma_f32 v158, v94, v7, v158
    v_mul_f32 v159, v159, v11
    v_fma_f32 v159, v95, v7, v159
    v_mul_f32 v160, v160, v11
    v_fma_f32 v160, v96, v7, v160
    v_mul_f32 v161, v161, v11
    v_fma_f32 v161, v97, v7, v161
    v_mul_f32 v162, v162, v11
    v_fma_f32 v162, v98, v7, v162
    v_mul_f32 v163, v163, v11
    v_fma_f32 v163, v99, v7, v163
    v_mul_f32 v164, v164, v11
    v_fma_f32 v164, v100, v7, v164
    v_mul_f32 v165, v165, v11
    v_fma_f32 v165, v101, v7, v165
    v_mul_f32 v166, v166, v11
    v_fma_f32 v166, v102, v7, v166
    v_mul_f32 v167, v167, v11
    v_fma_f32 v167, v103, v7, v167
    v_mul_f32 v168, v168, v11
    v_fma_f32 v168, v104, v7, v168
    v_mul_f32 v169, v169, v11
    v_fma_f32 v169, v105, v7, v169
    v_mul_f32 v170, v170, v11
    v_fma_f32 v170, v106, v7, v170
    v_mul_f32 v171, v171, v11
    v_fma_f32 v171, v107, v7, v171
    v_mul_f32 v172, v172, v11
    v_fma_f32 v172, v108, v7, v172
    v_mul_f32 v173, v173, v11
    v_fma_f32 v173, v109, v7, v173
    v_mul_f32 v174, v174, v11
    v_fma_f32 v174, v110, v7, v174
    v_mul_f32 v175, v175, v11
    v_fma_f32 v175, v111, v7, v175
    v_mul_f32 v176, v176, v11
    v_fma_f32 v176, v112, v7, v176
    v_mul_f32 v177, v177, v11
    v_fma_f32 v177, v113, v7, v177
    v_mul_f32 v178, v178, v11
    v_fma_f32 v178, v114, v7, v178
    v_mul_f32 v179, v179, v11
    v_fma_f32 v179, v115, v7, v179
    ds_read_b32 v84, v14 offset:8192
    ds_read_b32 v85, v14 offset:8448
    ds_read_b32 v86, v14 offset:8704
    ds_read_b32 v87, v14 offset:8960
    ds_read_b32 v88, v14 offset:9216
    ds_read_b32 v89, v14 offset:9472
    ds_read_b32 v90, v14 offset:9728
    ds_read_b32 v91, v14 offset:9984
    ds_read_b32 v92, v14 offset:10240
    ds_read_b32 v93, v14 offset:10496
    ds_read_b32 v94, v14 offset:10752
    ds_read_b32 v95, v14 offset:11008
    ds_read_b32 v96, v14 offset:11264
    ds_read_b32 v97, v14 offset:11520
    ds_read_b32 v98, v14 offset:11776
    ds_read_b32 v99, v14 offset:12032
    ds_read_b32 v100, v14 offset:12288
    ds_read_b32 v101, v14 offset:12544
    ds_read_b32 v102, v14 offset:12800
    ds_read_b32 v103, v14 offset:13056
    ds_read_b32 v104, v14 offset:13312
    ds_read_b32 v105, v14 offset:13568
    ds_read_b32 v106, v14 offset:13824
    ds_read_b32 v107, v14 offset:14080
    ds_read_b32 v108, v14 offset:14336
    ds_read_b32 v109, v14 offset:14592
    ds_read_b32 v110, v14 offset:14848
    ds_read_b32 v111, v14 offset:15104
    ds_read_b32 v112, v14 offset:15360
    ds_read_b32 v113, v14 offset:15616
    ds_read_b32 v114, v14 offset:15872
    ds_read_b32 v115, v14 offset:16128
    s_waitcnt lgkmcnt(0)
    v_mul_f32 v180, v180, v11
    v_fma_f32 v180, v84, v7, v180
    v_mul_f32 v181, v181, v11
    v_fma_f32 v181, v85, v7, v181
    v_mul_f32 v182, v182, v11
    v_fma_f32 v182, v86, v7, v182
    v_mul_f32 v183, v183, v11
    v_fma_f32 v183, v87, v7, v183
    v_mul_f32 v184, v184, v11
    v_fma_f32 v184, v88, v7, v184
    v_mul_f32 v185, v185, v11
    v_fma_f32 v185, v89, v7, v185
    v_mul_f32 v186, v186, v11
    v_fma_f32 v186, v90, v7, v186
    v_mul_f32 v187, v187, v11
    v_fma_f32 v187, v91, v7, v187
    v_mul_f32 v188, v188, v11
    v_fma_f32 v188, v92, v7, v188
    v_mul_f32 v189, v189, v11
    v_fma_f32 v189, v93, v7, v189
    v_mul_f32 v190, v190, v11
    v_fma_f32 v190, v94, v7, v190
    v_mul_f32 v191, v191, v11
    v_fma_f32 v191, v95, v7, v191
    v_mul_f32 v192, v192, v11
    v_fma_f32 v192, v96, v7, v192
    v_mul_f32 v193, v193, v11
    v_fma_f32 v193, v97, v7, v193
    v_mul_f32 v194, v194, v11
    v_fma_f32 v194, v98, v7, v194
    v_mul_f32 v195, v195, v11
    v_fma_f32 v195, v99, v7, v195
    v_mul_f32 v196, v196, v11
    v_fma_f32 v196, v100, v7, v196
    v_mul_f32 v197, v197, v11
    v_fma_f32 v197, v101, v7, v197
    v_mul_f32 v198, v198, v11
    v_fma_f32 v198, v102, v7, v198
    v_mul_f32 v199, v199, v11
    v_fma_f32 v199, v103, v7, v199
    v_mul_f32 v200, v200, v11
    v_fma_f32 v200, v104, v7, v200
    v_mul_f32 v201, v201, v11
    v_fma_f32 v201, v105, v7, v201
    v_mul_f32 v202, v202, v11
    v_fma_f32 v202, v106, v7, v202
    v_mul_f32 v203, v203, v11
    v_fma_f32 v203, v107, v7, v203
    v_mul_f32 v204, v204, v11
    v_fma_f32 v204, v108, v7, v204
    v_mul_f32 v205, v205, v11
    v_fma_f32 v205, v109, v7, v205
    v_mul_f32 v206, v206, v11
    v_fma_f32 v206, v110, v7, v206
    v_mul_f32 v207, v207, v11
    v_fma_f32 v207, v111, v7, v207
    v_mul_f32 v208, v208, v11
    v_fma_f32 v208, v112, v7, v208
    v_mul_f32 v209, v209, v11
    v_fma_f32 v209, v113, v7, v209
    v_mul_f32 v210, v210, v11
    v_fma_f32 v210, v114, v7, v210
    v_mul_f32 v211, v211, v11
    v_fma_f32 v211, v115, v7, v211
    s_lshl_b32 s28, s33, 5
    v_add_u32 v8, s28, v2
    v_cmp_gt_u32 vcc, 112, v8
    v_lshlrev_b32 v8, 13, v8
    v_lshl_add_u32 v8, v3, 3, v8
    s_and_saveexec_b64 s[34:35], vcc
    v_cvt_pk_bf16_f32 v84, v148, v149
    v_cvt_pk_bf16_f32 v85, v150, v151
    buffer_store_dwordx2 v[84:85], v8, s[24:27], 0 offen offset:0
    v_cvt_pk_bf16_f32 v86, v152, v153
    v_cvt_pk_bf16_f32 v87, v154, v155
    buffer_store_dwordx2 v[86:87], v8, s[24:27], 0 offen offset:16
    v_cvt_pk_bf16_f32 v88, v156, v157
    v_cvt_pk_bf16_f32 v89, v158, v159
    buffer_store_dwordx2 v[88:89], v8, s[24:27], 0 offen offset:32
    v_cvt_pk_bf16_f32 v90, v160, v161
    v_cvt_pk_bf16_f32 v91, v162, v163
    buffer_store_dwordx2 v[90:91], v8, s[24:27], 0 offen offset:48
    v_cvt_pk_bf16_f32 v92, v164, v165
    v_cvt_pk_bf16_f32 v93, v166, v167
    buffer_store_dwordx2 v[92:93], v8, s[24:27], 0 offen offset:64
    v_cvt_pk_bf16_f32 v94, v168, v169
    v_cvt_pk_bf16_f32 v95, v170, v171
    buffer_store_dwordx2 v[94:95], v8, s[24:27], 0 offen offset:80
    v_cvt_pk_bf16_f32 v96, v172, v173
    v_cvt_pk_bf16_f32 v97, v174, v175
    buffer_store_dwordx2 v[96:97], v8, s[24:27], 0 offen offset:96
    v_cvt_pk_bf16_f32 v98, v176, v177
    v_cvt_pk_bf16_f32 v99, v178, v179
    buffer_store_dwordx2 v[98:99], v8, s[24:27], 0 offen offset:112
    v_cvt_pk_bf16_f32 v100, v180, v181
    v_cvt_pk_bf16_f32 v101, v182, v183
    buffer_store_dwordx2 v[100:101], v8, s[24:27], 0 offen offset:128
    v_cvt_pk_bf16_f32 v102, v184, v185
    v_cvt_pk_bf16_f32 v103, v186, v187
    buffer_store_dwordx2 v[102:103], v8, s[24:27], 0 offen offset:144
    v_cvt_pk_bf16_f32 v104, v188, v189
    v_cvt_pk_bf16_f32 v105, v190, v191
    buffer_store_dwordx2 v[104:105], v8, s[24:27], 0 offen offset:160
    v_cvt_pk_bf16_f32 v106, v192, v193
    v_cvt_pk_bf16_f32 v107, v194, v195
    buffer_store_dwordx2 v[106:107], v8, s[24:27], 0 offen offset:176
    v_cvt_pk_bf16_f32 v108, v196, v197
    v_cvt_pk_bf16_f32 v109, v198, v199
    buffer_store_dwordx2 v[108:109], v8, s[24:27], 0 offen offset:192
    v_cvt_pk_bf16_f32 v110, v200, v201
    v_cvt_pk_bf16_f32 v111, v202, v203
    buffer_store_dwordx2 v[110:111], v8, s[24:27], 0 offen offset:208
    v_cvt_pk_bf16_f32 v112, v204, v205
    v_cvt_pk_bf16_f32 v113, v206, v207
    buffer_store_dwordx2 v[112:113], v8, s[24:27], 0 offen offset:224
    v_cvt_pk_bf16_f32 v114, v208, v209
    v_cvt_pk_bf16_f32 v115, v210, v211
    buffer_store_dwordx2 v[114:115], v8, s[24:27], 0 offen offset:240
    s_mov_b64 exec, s[34:35]
L_attn_end:
    s_endpgm
.globl oproj_kernel
.p2align 8
.type oproj_kernel,@function
oproj_kernel:
    s_cmp_ge_u32 s2, 256
    s_cbranch_scc1 L_op_end
    s_and_b32 s4, s2, 7
    s_lshr_b32 s5, s2, 7
    s_lshl_b32 s5, s5, 3
    s_add_u32 s4, s4, s5
    s_cmp_ge_u32 s4, 14
    s_cbranch_scc1 L_op_end
    s_load_dwordx4 s[40:43], s[0:1], 32
    s_load_dwordx2 s[48:49], s[0:1], 56
    v_and_b32 v1, 63, v0
    v_lshrrev_b32 v4, 6, v0
    s_nop 0
    v_readfirstlane_b32 s3, v4
    s_lshr_b32 s5, s2, 3
    s_and_b32 s5, s5, 15
    v_and_b32 v2, 31, v1
    v_lshrrev_b32 v3, 5, v1
    s_and_b32 s6, s3, 1
    s_lshr_b32 s7, s3, 1
    s_waitcnt lgkmcnt(0)
    s_lshl_b32 s28, s5, 6
    s_add_u32 s8, s40, s28
    s_addc_u32 s9, s41, 0
    s_sub_u32 s10, 4194304, s28
    s_mov_b32 s11, 0x00020000
    s_lshl_b32 s28, s4, 19
    s_add_u32 s12, s48, s28
    s_addc_u32 s13, s49, 0
    s_sub_u32 s14, 7340032, s28
    s_mov_b32 s15, 0x00020000
    s_lshl_b32 s28, s4, 16
    s_lshl_b32 s29, s5, 6
    s_add_u32 s28, s28, s29
    s_add_u32 s16, s42, s28
    s_addc_u32 s17, s43, 0
    s_sub_u32 s18, 917504, s28
    s_mov_b32 s19, 0x00020000
    v_lshrrev_b32 v4, 2, v1
    v_and_b32 v5, 3, v1
    v_lshlrev_b32 v5, 4, v5
    v_lshl_add_u32 v8, v4, 10, v5
    s_lshl_b32 s28, s6, 5
    v_add_u32 v4, s28, v2
    v_lshlrev_b32 v4, 13, v4
    v_lshl_add_u32 v9, v3, 4, v4
    s_lshl_b32 s28, s7, 7
    v_add_u32 v9, s28, v9
    s_lshl_b32 s28, s3, 3
    v_add_u32 v4, s28, v3
    v_and_b32 v5, 15, v4
    v_xor_b32 v5, v5, v2
    v_lshlrev_b32 v5, 4, v5
    v_lshl_add_u32 v96, v4, 13, v5
    v_xor_b32 v97, 32, v96
    v_add_u32 v97, 16384, v97
    v_xor_b32 v98, 64, v96
    v_add_u32 v98, 32768, v98
    v_xor_b32 v99, 96, v96
    v_add_u32 v99, 49152, v99
    s_lshl_b32 s28, s6, 5
    v_add_u32 v4, s28, v2
    v_and_b32 v5, 15, v4
    v_xor_b32 v5, v5, v3
    s_lshl_b32 s28, s7, 3
    v_xor_b32 v5, s28, v5
    v_lshlrev_b32 v5, 4, v5
    v_lshl_add_u32 v9, v4, 9, v5
    v_add_u32 v9, 16384, v9
    v_and_b32 v5, 15, v1
    v_lshrrev_b32 v6, 2, v5
    v_and_b32 v5, 3, v5
    v_lshlrev_b32 v5, 3, v5
    v_lshl_add_u32 v5, v6, 6, v5
    v_lshl_add_u32 v5, v3, 9, v5
    v_bfe_u32 v6, v1, 4, 1
    v_lshl_add_u32 v5, v6, 5, v5
    s_lshl_b32 s28, s7, 12
    v_add_u32 v10, s28, v5
    s_lshl_b32 s30, s3, 11
    s_add_u32 s30, s30, 0
    s_lshl_b32 s31, s3, 15
    s_add_u32 s31, s31, 0
    s_mov_b32 m0, s30
    s_add_u32 s30, s30, 1024
    buffer_load_dwordx4 v8, s[8:11], s31 offen lds
    s_add_u32 s31, s31, 16384
    s_mov_b32 m0, s30
    s_add_u32 s30, s30, 1024
    buffer_load_dwordx4 v8, s[8:11], s31 offen lds
    s_add_u32 s31, s31, 16384
    s_lshl_b32 s30, s3, 12
    s_add_u32 s30, s30, 16384
    s_mov_b32 s31, 0
    s_mov_b32 m0, s30
    s_add_u32 s30, s30, 1024
    buffer_load_dwordx4 v96, s[12:15], s31 offen lds
    s_mov_b32 m0, s30
    s_add_u32 s30, s30, 1024
    buffer_load_dwordx4 v97, s[12:15], s31 offen lds
    s_mov_b32 m0, s30
    s_add_u32 s30, s30, 1024
    buffer_load_dwordx4 v98, s[12:15], s31 offen lds
    s_mov_b32 m0, s30
    s_add_u32 s30, s30, 1024
    buffer_load_dwordx4 v99, s[12:15], s31 offen lds
    s_lshl_b32 s30, s3, 11
    s_add_u32 s30, s30, 49152
    s_lshl_b32 s31, s3, 15
    s_add_u32 s31, s31, 262144
    s_mov_b32 m0, s30
    s_add_u32 s30, s30, 1024
    buffer_load_dwordx4 v8, s[8:11], s31 offen lds
    s_add_u32 s31, s31, 16384
    s_mov_b32 m0, s30
    s_add_u32 s30, s30, 1024
    buffer_load_dwordx4 v8, s[8:11], s31 offen lds
    s_add_u32 s31, s31, 16384
    s_lshl_b32 s30, s3, 12
    s_add_u32 s30, s30, 65536
    s_mov_b32 s31, 512
    s_mov_b32 m0, s30
    s_add_u32 s30, s30, 1024
    buffer_load_dwordx4 v96, s[12:15], s31 offen lds
    s_mov_b32 m0, s30
    s_add_u32 s30, s30, 1024
    buffer_load_dwordx4 v97, s[12:15], s31 offen lds
    s_mov_b32 m0, s30
    s_add_u32 s30, s30, 1024
    buffer_load_dwordx4 v98, s[12:15], s31 offen lds
    s_mov_b32 m0, s30
    s_add_u32 s30, s30, 1024
    buffer_load_dwordx4 v99, s[12:15], s31 offen lds
    s_waitcnt vmcnt(6)
    s_barrier
    s_lshl_b32 s30, s3, 11
    s_add_u32 s30, s30, 98304
    s_lshl_b32 s31, s3, 15
    s_add_u32 s31, s31, 524288
    s_mov_b32 m0, s30
    s_add_u32 s30, s30, 1024
    buffer_load_dwordx4 v8, s[8:11], s31 offen lds
    s_add_u32 s31, s31, 16384
    s_mov_b32 m0, s30
    s_add_u32 s30, s30, 1024
    buffer_load_dwordx4 v8, s[8:11], s31 offen lds
    s_add_u32 s31, s31, 16384
    s_lshl_b32 s30, s3, 12
    s_add_u32 s30, s30, 114688
    s_mov_b32 s31, 1024
    s_mov_b32 m0, s30
    s_add_u32 s30, s30, 1024
    buffer_load_dwordx4 v96, s[12:15], s31 offen lds
    s_mov_b32 m0, s30
    s_add_u32 s30, s30, 1024
    buffer_load_dwordx4 v97, s[12:15], s31 offen lds
    s_mov_b32 m0, s30
    s_add_u32 s30, s30, 1024
    buffer_load_dwordx4 v98, s[12:15], s31 offen lds
    s_mov_b32 m0, s30
    s_add_u32 s30, s30, 1024
    buffer_load_dwordx4 v99, s[12:15], s31 offen lds
    v_xor_b32 v4, 0, v9
    ds_read_b128 v[32:35], v4 offset:0
    v_xor_b32 v4, 32, v9
    ds_read_b128 v[36:39], v4 offset:0
    v_xor_b32 v4, 64, v9
    ds_read_b128 v[40:43], v4 offset:0
    v_xor_b32 v4, 96, v9
    ds_read_b128 v[44:47], v4 offset:0
    ds_read_b64_tr_b16 v[80:81], v10 offset:0
    ds_read_b64_tr_b16 v[82:83], v10 offset:256
    ds_read_b64_tr_b16 v[84:85], v10 offset:1024
    ds_read_b64_tr_b16 v[86:87], v10 offset:1280
    ds_read_b64_tr_b16 v[88:89], v10 offset:2048
    ds_read_b64_tr_b16 v[90:91], v10 offset:2304
    ds_read_b64_tr_b16 v[92:93], v10 offset:3072
    ds_read_b64_tr_b16 v[94:95], v10 offset:3328
    s_waitcnt lgkmcnt(6)
    v_mfma_f32_32x32x16_bf16 v[16:31], v[80:83], v[32:35], 0
    s_waitcnt lgkmcnt(4)
    v_mfma_f32_32x32x16_bf16 v[16:31], v[84:87], v[36:39], v[16:31]
    s_waitcnt lgkmcnt(2)
    v_mfma_f32_32x32x16_bf16 v[16:31], v[88:91], v[40:43], v[16:31]
    s_waitcnt lgkmcnt(0)
    v_mfma_f32_32x32x16_bf16 v[16:31], v[92:95], v[44:47], v[16:31]
    s_waitcnt vmcnt(6)
    s_barrier
    s_lshl_b32 s30, s3, 11
    s_add_u32 s30, s30, 0
    s_lshl_b32 s31, s3, 15
    s_add_u32 s31, s31, 786432
    s_mov_b32 m0, s30
    s_add_u32 s30, s30, 1024
    buffer_load_dwordx4 v8, s[8:11], s31 offen lds
    s_add_u32 s31, s31, 16384
    s_mov_b32 m0, s30
    s_add_u32 s30, s30, 1024
    buffer_load_dwordx4 v8, s[8:11], s31 offen lds
    s_add_u32 s31, s31, 16384
    s_lshl_b32 s30, s3, 12
    s_add_u32 s30, s30, 16384
    s_mov_b32 s31, 1536
    s_mov_b32 m0, s30
    s_add_u32 s30, s30, 1024
    buffer_load_dwordx4 v96, s[12:15], s31 offen lds
    s_mov_b32 m0, s30
    s_add_u32 s30, s30, 1024
    buffer_load_dwordx4 v97, s[12:15], s31 offen lds
    s_mov_b32 m0, s30
    s_add_u32 s30, s30, 1024
    buffer_load_dwordx4 v98, s[12:15], s31 offen lds
    s_mov_b32 m0, s30
    s_add_u32 s30, s30, 1024
    buffer_load_dwordx4 v99, s[12:15], s31 offen lds
    v_xor_b32 v4, 0, v9
    ds_read_b128 v[32:35], v4 offset:49152
    v_xor_b32 v4, 32, v9
    ds_read_b128 v[36:39], v4 offset:49152
    v_xor_b32 v4, 64, v9
    ds_read_b128 v[40:43], v4 offset:49152
    v_xor_b32 v4, 96, v9
    ds_read_b128 v[44:47], v4 offset:49152
    ds_read_b64_tr_b16 v[80:81], v10 offset:49152
    ds_read_b64_tr_b16 v[82:83], v10 offset:49408
    ds_read_b64_tr_b16 v[84:85], v10 offset:50176
    ds_read_b64_tr_b16 v[86:87], v10 offset:50432
    ds_read_b64_tr_b16 v[88:89], v10 offset:51200
    ds_read_b64_tr_b16 v[90:91], v10 offset:51456
    ds_read_b64_tr_b16 v[92:93], v10 offset:52224
    ds_read_b64_tr_b16 v[94:95], v10 offset:52480
    s_waitcnt lgkmcnt(6)
    v_mfma_f32_32x32x16_bf16 v[16:31], v[80:83], v[32:35], v[16:31]
    s_waitcnt lgkmcnt(4)
    v_mfma_f32_32x32x16_bf16 v[16:31], v[84:87], v[36:39], v[16:31]
    s_waitcnt lgkmcnt(2)
    v_mfma_f32_32x32x16_bf16 v[16:31], v[88:91], v[40:43], v[16:31]
    s_waitcnt lgkmcnt(0)
    v_mfma_f32_32x32x16_bf16 v[16:31], v[92:95], v[44:47], v[16:31]
    s_waitcnt vmcnt(6)
    s_barrier
    s_lshl_b32 s30, s3, 11
    s_add_u32 s30, s30, 49152
    s_lshl_b32 s31, s3, 15
    s_add_u32 s31, s31, 1048576
    s_mov_b32 m0, s30
    s_add_u32 s30, s30, 1024
    buffer_load_dwordx4 v8, s[8:11], s31 offen lds
    s_add_u32 s31, s31, 16384
    s_mov_b32 m0, s30
    s_add_u32 s30, s30, 1024
    buffer_load_dwordx4 v8, s[8:11], s31 offen lds
    s_add_u32 s31, s31, 16384
    s_lshl_b32 s30, s3, 12
    s_add_u32 s30, s30, 65536
    s_mov_b32 s31, 2048
    s_mov_b32 m0, s30
    s_add_u32 s30, s30, 1024
    buffer_load_dwordx4 v96, s[12:15], s31 offen lds
    s_mov_b32 m0, s30
    s_add_u32 s30, s30, 1024
    buffer_load_dwordx4 v97, s[12:15], s31 offen lds
    s_mov_b32 m0, s30
    s_add_u32 s30, s30, 1024
    buffer_load_dwordx4 v98, s[12:15], s31 offen lds
    s_mov_b32 m0, s30
    s_add_u32 s30, s30, 1024
    buffer_load_dwordx4 v99, s[12:15], s31 offen lds
    v_add_u32 v10, 0x10000, v10
    v_add_u32 v9, 0x10000, v9
    v_xor_b32 v4, 0, v9
    ds_read_b128 v[32:35], v4 offset:32768
    v_xor_b32 v4, 32, v9
    ds_read_b128 v[36:39], v4 offset:32768
    v_xor_b32 v4, 64, v9
    ds_read_b128 v[40:43], v4 offset:32768
    v_xor_b32 v4, 96, v9
    ds_read_b128 v[44:47], v4 offset:32768
    ds_read_b64_tr_b16 v[80:81], v10 offset:32768
    ds_read_b64_tr_b16 v[82:83], v10 offset:33024
    ds_read_b64_tr_b16 v[84:85], v10 offset:33792
    ds_read_b64_tr_b16 v[86:87], v10 offset:34048
    ds_read_b64_tr_b16 v[88:89], v10 offset:34816
    ds_read_b64_tr_b16 v[90:91], v10 offset:35072
    ds_read_b64_tr_b16 v[92:93], v10 offset:35840
    ds_read_b64_tr_b16 v[94:95], v10 offset:36096
    s_waitcnt lgkmcnt(6)
    v_mfma_f32_32x32x16_bf16 v[16:31], v[80:83], v[32:35], v[16:31]
    s_waitcnt lgkmcnt(4)
    v_mfma_f32_32x32x16_bf16 v[16:31], v[84:87], v[36:39], v[16:31]
    s_waitcnt lgkmcnt(2)
    v_mfma_f32_32x32x16_bf16 v[16:31], v[88:91], v[40:43], v[16:31]
    s_waitcnt lgkmcnt(0)
    v_mfma_f32_32x32x16_bf16 v[16:31], v[92:95], v[44:47], v[16:31]
    v_subrev_u32 v10, 0x10000, v10
    v_subrev_u32 v9, 0x10000, v9
    s_waitcnt vmcnt(6)
    s_barrier
    s_lshl_b32 s30, s3, 11
    s_add_u32 s30, s30, 98304
    s_lshl_b32 s31, s3, 15
    s_add_u32 s31, s31, 1310720
    s_mov_b32 m0, s30
    s_add_u32 s30, s30, 1024
    buffer_load_dwordx4 v8, s[8:11], s31 offen lds
    s_add_u32 s31, s31, 16384
    s_mov_b32 m0, s30
    s_add_u32 s30, s30, 1024
    buffer_load_dwordx4 v8, s[8:11], s31 offen lds
    s_add_u32 s31, s31, 16384
    s_lshl_b32 s30, s3, 12
    s_add_u32 s30, s30, 114688
    s_mov_b32 s31, 2560
    s_mov_b32 m0, s30
    s_add_u32 s30, s30, 1024
    buffer_load_dwordx4 v96, s[12:15], s31 offen lds
    s_mov_b32 m0, s30
    s_add_u32 s30, s30, 1024
    buffer_load_dwordx4 v97, s[12:15], s31 offen lds
    s_mov_b32 m0, s30
    s_add_u32 s30, s30, 1024
    buffer_load_dwordx4 v98, s[12:15], s31 offen lds
    s_mov_b32 m0, s30
    s_add_u32 s30, s30, 1024
    buffer_load_dwordx4 v99, s[12:15], s31 offen lds
    v_xor_b32 v4, 0, v9
    ds_read_b128 v[32:35], v4 offset:0
    v_xor_b32 v4, 32, v9
    ds_read_b128 v[36:39], v4 offset:0
    v_xor_b32 v4, 64, v9
    ds_read_b128 v[40:43], v4 offset:0
    v_xor_b32 v4, 96, v9
    ds_read_b128 v[44:47], v4 offset:0
    ds_read_b64_tr_b16 v[80:81], v10 offset:0
    ds_read_b64_tr_b16 v[82:83], v10 offset:256
    ds_read_b64_tr_b16 v[84:85], v10 offset:1024
    ds_read_b64_tr_b16 v[86:87], v10 offset:1280
    ds_read_b64_tr_b16 v[88:89], v10 offset:2048
    ds_read_b64_tr_b16 v[90:91], v10 offset:2304
    ds_read_b64_tr_b16 v[92:93], v10 offset:3072
    ds_read_b64_tr_b16 v[94:95], v10 offset:3328
    s_waitcnt lgkmcnt(6)
    v_mfma_f32_32x32x16_bf16 v[16:31], v[80:83], v[32:35], v[16:31]
    s_waitcnt lgkmcnt(4)
    v_mfma_f32_32x32x16_bf16 v[16:31], v[84:87], v[36:39], v[16:31]
    s_waitcnt lgkmcnt(2)
    v_mfma_f32_32x32x16_bf16 v[16:31], v[88:91], v[40:43], v[16:31]
    s_waitcnt lgkmcnt(0)
    v_mfma_f32_32x32x16_bf16 v[16:31], v[92:95], v[44:47], v[16:31]
    s_waitcnt vmcnt(6)
    s_barrier
    s_lshl_b32 s30, s3, 11
    s_add_u32 s30, s30, 0
    s_lshl_b32 s31, s3, 15
    s_add_u32 s31, s31, 1572864
    s_mov_b32 m0, s30
    s_add_u32 s30, s30, 1024
    buffer_load_dwordx4 v8, s[8:11], s31 offen lds
    s_add_u32 s31, s31, 16384
    s_mov_b32 m0, s30
    s_add_u32 s30, s30, 1024
    buffer_load_dwordx4 v8, s[8:11], s31 offen lds
    s_add_u32 s31, s31, 16384
    s_lshl_b32 s30, s3, 12
    s_add_u32 s30, s30, 16384
    s_mov_b32 s31, 3072
    s_mov_b32 m0, s30
    s_add_u32 s30, s30, 1024
    buffer_load_dwordx4 v96, s[12:15], s31 offen lds
    s_mov_b32 m0, s30
    s_add_u32 s30, s30, 1024
    buffer_load_dwordx4 v97, s[12:15], s31 offen lds
    s_mov_b32 m0, s30
    s_add_u32 s30, s30, 1024
    buffer_load_dwordx4 v98, s[12:15], s31 offen lds
    s_mov_b32 m0, s30
    s_add_u32 s30, s30, 1024
    buffer_load_dwordx4 v99, s[12:15], s31 offen lds
    v_xor_b32 v4, 0, v9
    ds_read_b128 v[32:35], v4 offset:49152
    v_xor_b32 v4, 32, v9
    ds_read_b128 v[36:39], v4 offset:49152
    v_xor_b32 v4, 64, v9
    ds_read_b128 v[40:43], v4 offset:49152
    v_xor_b32 v4, 96, v9
    ds_read_b128 v[44:47], v4 offset:49152
    ds_read_b64_tr_b16 v[80:81], v10 offset:49152
    ds_read_b64_tr_b16 v[82:83], v10 offset:49408
    ds_read_b64_tr_b16 v[84:85], v10 offset:50176
    ds_read_b64_tr_b16 v[86:87], v10 offset:50432
    ds_read_b64_tr_b16 v[88:89], v10 offset:51200
    ds_read_b64_tr_b16 v[90:91], v10 offset:51456
    ds_read_b64_tr_b16 v[92:93], v10 offset:52224
    ds_read_b64_tr_b16 v[94:95], v10 offset:52480
    s_waitcnt lgkmcnt(6)
    v_mfma_f32_32x32x16_bf16 v[16:31], v[80:83], v[32:35], v[16:31]
    s_waitcnt lgkmcnt(4)
    v_mfma_f32_32x32x16_bf16 v[16:31], v[84:87], v[36:39], v[16:31]
    s_waitcnt lgkmcnt(2)
    v_mfma_f32_32x32x16_bf16 v[16:31], v[88:91], v[40:43], v[16:31]
    s_waitcnt lgkmcnt(0)
    v_mfma_f32_32x32x16_bf16 v[16:31], v[92:95], v[44:47], v[16:31]
    s_waitcnt vmcnt(6)
    s_barrier
    s_lshl_b32 s30, s3, 11
    s_add_u32 s30, s30, 49152
    s_lshl_b32 s31, s3, 15
    s_add_u32 s31, s31, 1835008
    s_mov_b32 m0, s30
    s_add_u32 s30, s30, 1024
    buffer_load_dwordx4 v8, s[8:11], s31 offen lds
    s_add_u32 s31, s31, 16384
    s_mov_b32 m0, s30
    s_add_u32 s30, s30, 1024
    buffer_load_dwordx4 v8, s[8:11], s31 offen lds
    s_add_u32 s31, s31, 16384
    s_lshl_b32 s30, s3, 12
    s_add_u32 s30, s30, 65536
    s_mov_b32 s31, 3584
    s_mov_b32 m0, s30
    s_add_u32 s30, s30, 1024
    buffer_load_dwordx4 v96, s[12:15], s31 offen lds
    s_mov_b32 m0, s30
    s_add_u32 s30, s30, 1024
    buffer_load_dwordx4 v97, s[12:15], s31 offen lds
    s_mov_b32 m0, s30
    s_add_u32 s30, s30, 1024
    buffer_load_dwordx4 v98, s[12:15], s31 offen lds
    s_mov_b32 m0, s30
    s_add_u32 s30, s30, 1024
    buffer_load_dwordx4 v99, s[12:15], s31 offen lds
    v_add_u32 v10, 0x10000, v10
    v_add_u32 v9, 0x10000, v9
    v_xor_b32 v4, 0, v9
    ds_read_b128 v[32:35], v4 offset:32768
    v_xor_b32 v4, 32, v9
    ds_read_b128 v[36:39], v4 offset:32768
    v_xor_b32 v4, 64, v9
    ds_read_b128 v[40:43], v4 offset:32768
    v_xor_b32 v4, 96, v9
    ds_read_b128 v[44:47], v4 offset:32768
    ds_read_b64_tr_b16 v[80:81], v10 offset:32768
    ds_read_b64_tr_b16 v[82:83], v10 offset:33024
    ds_read_b64_tr_b16 v[84:85], v10 offset:33792
    ds_read_b64_tr_b16 v[86:87], v10 offset:34048
    ds_read_b64_tr_b16 v[88:89], v10 offset:34816
    ds_read_b64_tr_b16 v[90:91], v10 offset:35072
    ds_read_b64_tr_b16 v[92:93], v10 offset:35840
    ds_read_b64_tr_b16 v[94:95], v10 offset:36096
    s_waitcnt lgkmcnt(6)
    v_mfma_f32_32x32x16_bf16 v[16:31], v[80:83], v[32:35], v[16:31]
    s_waitcnt lgkmcnt(4)
    v_mfma_f32_32x32x16_bf16 v[16:31], v[84:87], v[36:39], v[16:31]
    s_waitcnt lgkmcnt(2)
    v_mfma_f32_32x32x16_bf16 v[16:31], v[88:91], v[40:43], v[16:31]
    s_waitcnt lgkmcnt(0)
    v_mfma_f32_32x32x16_bf16 v[16:31], v[92:95], v[44:47], v[16:31]
    v_subrev_u32 v10, 0x10000, v10
    v_subrev_u32 v9, 0x10000, v9
    s_waitcnt vmcnt(6)
    s_barrier
    s_lshl_b32 s30, s3, 11
    s_add_u32 s30, s30, 98304
    s_lshl_b32 s31, s3, 15
    s_add_u32 s31, s31, 2097152
    s_mov_b32 m0, s30
    s_add_u32 s30, s30, 1024
    buffer_load_dwordx4 v8, s[8:11], s31 offen lds
    s_add_u32 s31, s31, 16384
    s_mov_b32 m0, s30
    s_add_u32 s30, s30, 1024
    buffer_load_dwordx4 v8, s[8:11], s31 offen lds
    s_add_u32 s31, s31, 16384
    s_lshl_b32 s30, s3, 12
    s_add_u32 s30, s30, 114688
    s_mov_b32 s31, 4096
    s_mov_b32 m0, s30
    s_add_u32 s30, s30, 1024
    buffer_load_dwordx4 v96, s[12:15], s31 offen lds
    s_mov_b32 m0, s30
    s_add_u32 s30, s30, 1024
    buffer_load_dwordx4 v97, s[12:15], s31 offen lds
    s_mov_b32 m0, s30
    s_add_u32 s30, s30, 1024
    buffer_load_dwordx4 v98, s[12:15], s31 offen lds
    s_mov_b32 m0, s30
    s_add_u32 s30, s30, 1024
    buffer_load_dwordx4 v99, s[12:15], s31 offen lds
    v_xor_b32 v4, 0, v9
    ds_read_b128 v[32:35], v4 offset:0
    v_xor_b32 v4, 32, v9
    ds_read_b128 v[36:39], v4 offset:0
    v_xor_b32 v4, 64, v9
    ds_read_b128 v[40:43], v4 offset:0
    v_xor_b32 v4, 96, v9
    ds_read_b128 v[44:47], v4 offset:0
    ds_read_b64_tr_b16 v[80:81], v10 offset:0
    ds_read_b64_tr_b16 v[82:83], v10 offset:256
    ds_read_b64_tr_b16 v[84:85], v10 offset:1024
    ds_read_b64_tr_b16 v[86:87], v10 offset:1280
    ds_read_b64_tr_b16 v[88:89], v10 offset:2048
    ds_read_b64_tr_b16 v[90:91], v10 offset:2304
    ds_read_b64_tr_b16 v[92:93], v10 offset:3072
    ds_read_b64_tr_b16 v[94:95], v10 offset:3328
    s_waitcnt lgkmcnt(6)
    v_mfma_f32_32x32x16_bf16 v[16:31], v[80:83], v[32:35], v[16:31]
    s_waitcnt lgkmcnt(4)
    v_mfma_f32_32x32x16_bf16 v[16:31], v[84:87], v[36:39], v[16:31]
    s_waitcnt lgkmcnt(2)
    v_mfma_f32_32x32x16_bf16 v[16:31], v[88:91], v[40:43], v[16:31]
    s_waitcnt lgkmcnt(0)
    v_mfma_f32_32x32x16_bf16 v[16:31], v[92:95], v[44:47], v[16:31]
    s_waitcnt vmcnt(6)
    s_barrier
    s_lshl_b32 s30, s3, 11
    s_add_u32 s30, s30, 0
    s_lshl_b32 s31, s3, 15
    s_add_u32 s31, s31, 2359296
    s_mov_b32 m0, s30
    s_add_u32 s30, s30, 1024
    buffer_load_dwordx4 v8, s[8:11], s31 offen lds
    s_add_u32 s31, s31, 16384
    s_mov_b32 m0, s30
    s_add_u32 s30, s30, 1024
    buffer_load_dwordx4 v8, s[8:11], s31 offen lds
    s_add_u32 s31, s31, 16384
    s_lshl_b32 s30, s3, 12
    s_add_u32 s30, s30, 16384
    s_mov_b32 s31, 4608
    s_mov_b32 m0, s30
    s_add_u32 s30, s30, 1024
    buffer_load_dwordx4 v96, s[12:15], s31 offen lds
    s_mov_b32 m0, s30
    s_add_u32 s30, s30, 1024
    buffer_load_dwordx4 v97, s[12:15], s31 offen lds
    s_mov_b32 m0, s30
    s_add_u32 s30, s30, 1024
    buffer_load_dwordx4 v98, s[12:15], s31 offen lds
    s_mov_b32 m0, s30
    s_add_u32 s30, s30, 1024
    buffer_load_dwordx4 v99, s[12:15], s31 offen lds
    v_xor_b32 v4, 0, v9
    ds_read_b128 v[32:35], v4 offset:49152
    v_xor_b32 v4, 32, v9
    ds_read_b128 v[36:39], v4 offset:49152
    v_xor_b32 v4, 64, v9
    ds_read_b128 v[40:43], v4 offset:49152
    v_xor_b32 v4, 96, v9
    ds_read_b128 v[44:47], v4 offset:49152
    ds_read_b64_tr_b16 v[80:81], v10 offset:49152
    ds_read_b64_tr_b16 v[82:83], v10 offset:49408
    ds_read_b64_tr_b16 v[84:85], v10 offset:50176
    ds_read_b64_tr_b16 v[86:87], v10 offset:50432
    ds_read_b64_tr_b16 v[88:89], v10 offset:51200
    ds_read_b64_tr_b16 v[90:91], v10 offset:51456
    ds_read_b64_tr_b16 v[92:93], v10 offset:52224
    ds_read_b64_tr_b16 v[94:95], v10 offset:52480
    s_waitcnt lgkmcnt(6)
    v_mfma_f32_32x32x16_bf16 v[16:31], v[80:83], v[32:35], v[16:31]
    s_waitcnt lgkmcnt(4)
    v_mfma_f32_32x32x16_bf16 v[16:31], v[84:87], v[36:39], v[16:31]
    s_waitcnt lgkmcnt(2)
    v_mfma_f32_32x32x16_bf16 v[16:31], v[88:91], v[40:43], v[16:31]
    s_waitcnt lgkmcnt(0)
    v_mfma_f32_32x32x16_bf16 v[16:31], v[92:95], v[44:47], v[16:31]
    s_waitcnt vmcnt(6)
    s_barrier
    s_lshl_b32 s30, s3, 11
    s_add_u32 s30, s30, 49152
    s_lshl_b32 s31, s3, 15
    s_add_u32 s31, s31, 2621440
    s_mov_b32 m0, s30
    s_add_u32 s30, s30, 1024
    buffer_load_dwordx4 v8, s[8:11], s31 offen lds
    s_add_u32 s31, s31, 16384
    s_mov_b32 m0, s30
    s_add_u32 s30, s30, 1024
    buffer_load_dwordx4 v8, s[8:11], s31 offen lds
    s_add_u32 s31, s31, 16384
    s_lshl_b32 s30, s3, 12
    s_add_u32 s30, s30, 65536
    s_mov_b32 s31, 5120
    s_mov_b32 m0, s30
    s_add_u32 s30, s30, 1024
    buffer_load_dwordx4 v96, s[12:15], s31 offen lds
    s_mov_b32 m0, s30
    s_add_u32 s30, s30, 1024
    buffer_load_dwordx4 v97, s[12:15], s31 offen lds
    s_mov_b32 m0, s30
    s_add_u32 s30, s30, 1024
    buffer_load_dwordx4 v98, s[12:15], s31 offen lds
    s_mov_b32 m0, s30
    s_add_u32 s30, s30, 1024
    buffer_load_dwordx4 v99, s[12:15], s31 offen lds
    v_add_u32 v10, 0x10000, v10
    v_add_u32 v9, 0x10000, v9
    v_xor_b32 v4, 0, v9
    ds_read_b128 v[32:35], v4 offset:32768
    v_xor_b32 v4, 32, v9
    ds_read_b128 v[36:39], v4 offset:32768
    v_xor_b32 v4, 64, v9
    ds_read_b128 v[40:43], v4 offset:32768
    v_xor_b32 v4, 96, v9
    ds_read_b128 v[44:47], v4 offset:32768
    ds_read_b64_tr_b16 v[80:81], v10 offset:32768
    ds_read_b64_tr_b16 v[82:83], v10 offset:33024
    ds_read_b64_tr_b16 v[84:85], v10 offset:33792
    ds_read_b64_tr_b16 v[86:87], v10 offset:34048
    ds_read_b64_tr_b16 v[88:89], v10 offset:34816
    ds_read_b64_tr_b16 v[90:91], v10 offset:35072
    ds_read_b64_tr_b16 v[92:93], v10 offset:35840
    ds_read_b64_tr_b16 v[94:95], v10 offset:36096
    s_waitcnt lgkmcnt(6)
    v_mfma_f32_32x32x16_bf16 v[16:31], v[80:83], v[32:35], v[16:31]
    s_waitcnt lgkmcnt(4)
    v_mfma_f32_32x32x16_bf16 v[16:31], v[84:87], v[36:39], v[16:31]
    s_waitcnt lgkmcnt(2)
    v_mfma_f32_32x32x16_bf16 v[16:31], v[88:91], v[40:43], v[16:31]
    s_waitcnt lgkmcnt(0)
    v_mfma_f32_32x32x16_bf16 v[16:31], v[92:95], v[44:47], v[16:31]
    v_subrev_u32 v10, 0x10000, v10
    v_subrev_u32 v9, 0x10000, v9
    s_waitcnt vmcnt(6)
    s_barrier
    s_lshl_b32 s30, s3, 11
    s_add_u32 s30, s30, 98304
    s_lshl_b32 s31, s3, 15
    s_add_u32 s31, s31, 2883584
    s_mov_b32 m0, s30
    s_add_u32 s30, s30, 1024
    buffer_load_dwordx4 v8, s[8:11], s31 offen lds
    s_add_u32 s31, s31, 16384
    s_mov_b32 m0, s30
    s_add_u32 s30, s30, 1024
    buffer_load_dwordx4 v8, s[8:11], s31 offen lds
    s_add_u32 s31, s31, 16384
    s_lshl_b32 s30, s3, 12
    s_add_u32 s30, s30, 114688
    s_mov_b32 s31, 5632
    s_mov_b32 m0, s30
    s_add_u32 s30, s30, 1024
    buffer_load_dwordx4 v96, s[12:15], s31 offen lds
    s_mov_b32 m0, s30
    s_add_u32 s30, s30, 1024
    buffer_load_dwordx4 v97, s[12:15], s31 offen lds
    s_mov_b32 m0, s30
    s_add_u32 s30, s30, 1024
    buffer_load_dwordx4 v98, s[12:15], s31 offen lds
    s_mov_b32 m0, s30
    s_add_u32 s30, s30, 1024
    buffer_load_dwordx4 v99, s[12:15], s31 offen lds
    v_xor_b32 v4, 0, v9
    ds_read_b128 v[32:35], v4 offset:0
    v_xor_b32 v4, 32, v9
    ds_read_b128 v[36:39], v4 offset:0
    v_xor_b32 v4, 64, v9
    ds_read_b128 v[40:43], v4 offset:0
    v_xor_b32 v4, 96, v9
    ds_read_b128 v[44:47], v4 offset:0
    ds_read_b64_tr_b16 v[80:81], v10 offset:0
    ds_read_b64_tr_b16 v[82:83], v10 offset:256
    ds_read_b64_tr_b16 v[84:85], v10 offset:1024
    ds_read_b64_tr_b16 v[86:87], v10 offset:1280
    ds_read_b64_tr_b16 v[88:89], v10 offset:2048
    ds_read_b64_tr_b16 v[90:91], v10 offset:2304
    ds_read_b64_tr_b16 v[92:93], v10 offset:3072
    ds_read_b64_tr_b16 v[94:95], v10 offset:3328
    s_waitcnt lgkmcnt(6)
    v_mfma_f32_32x32x16_bf16 v[16:31], v[80:83], v[32:35], v[16:31]
    s_waitcnt lgkmcnt(4)
    v_mfma_f32_32x32x16_bf16 v[16:31], v[84:87], v[36:39], v[16:31]
    s_waitcnt lgkmcnt(2)
    v_mfma_f32_32x32x16_bf16 v[16:31], v[88:91], v[40:43], v[16:31]
    s_waitcnt lgkmcnt(0)
    v_mfma_f32_32x32x16_bf16 v[16:31], v[92:95], v[44:47], v[16:31]
    s_waitcnt vmcnt(6)
    s_barrier
    s_lshl_b32 s30, s3, 11
    s_add_u32 s30, s30, 0
    s_lshl_b32 s31, s3, 15
    s_add_u32 s31, s31, 3145728
    s_mov_b32 m0, s30
    s_add_u32 s30, s30, 1024
    buffer_load_dwordx4 v8, s[8:11], s31 offen lds
    s_add_u32 s31, s31, 16384
    s_mov_b32 m0, s30
    s_add_u32 s30, s30, 1024
    buffer_load_dwordx4 v8, s[8:11], s31 offen lds
    s_add_u32 s31, s31, 16384
    s_lshl_b32 s30, s3, 12
    s_add_u32 s30, s30, 16384
    s_mov_b32 s31, 6144
    s_mov_b32 m0, s30
    s_add_u32 s30, s30, 1024
    buffer_load_dwordx4 v96, s[12:15], s31 offen lds
    s_mov_b32 m0, s30
    s_add_u32 s30, s30, 1024
    buffer_load_dwordx4 v97, s[12:15], s31 offen lds
    s_mov_b32 m0, s30
    s_add_u32 s30, s30, 1024
    buffer_load_dwordx4 v98, s[12:15], s31 offen lds
    s_mov_b32 m0, s30
    s_add_u32 s30, s30, 1024
    buffer_load_dwordx4 v99, s[12:15], s31 offen lds
    v_xor_b32 v4, 0, v9
    ds_read_b128 v[32:35], v4 offset:49152
    v_xor_b32 v4, 32, v9
    ds_read_b128 v[36:39], v4 offset:49152
    v_xor_b32 v4, 64, v9
    ds_read_b128 v[40:43], v4 offset:49152
    v_xor_b32 v4, 96, v9
    ds_read_b128 v[44:47], v4 offset:49152
    ds_read_b64_tr_b16 v[80:81], v10 offset:49152
    ds_read_b64_tr_b16 v[82:83], v10 offset:49408
    ds_read_b64_tr_b16 v[84:85], v10 offset:50176
    ds_read_b64_tr_b16 v[86:87], v10 offset:50432
    ds_read_b64_tr_b16 v[88:89], v10 offset:51200
    ds_read_b64_tr_b16 v[90:91], v10 offset:51456
    ds_read_b64_tr_b16 v[92:93], v10 offset:52224
    ds_read_b64_tr_b16 v[94:95], v10 offset:52480
    s_waitcnt lgkmcnt(6)
    v_mfma_f32_32x32x16_bf16 v[16:31], v[80:83], v[32:35], v[16:31]
    s_waitcnt lgkmcnt(4)
    v_mfma_f32_32x32x16_bf16 v[16:31], v[84:87], v[36:39], v[16:31]
    s_waitcnt lgkmcnt(2)
    v_mfma_f32_32x32x16_bf16 v[16:31], v[88:91], v[40:43], v[16:31]
    s_waitcnt lgkmcnt(0)
    v_mfma_f32_32x32x16_bf16 v[16:31], v[92:95], v[44:47], v[16:31]
    s_waitcnt vmcnt(6)
    s_barrier
    s_lshl_b32 s30, s3, 11
    s_add_u32 s30, s30, 49152
    s_lshl_b32 s31, s3, 15
    s_add_u32 s31, s31, 3407872
    s_mov_b32 m0, s30
    s_add_u32 s30, s30, 1024
    buffer_load_dwordx4 v8, s[8:11], s31 offen lds
    s_add_u32 s31, s31, 16384
    s_mov_b32 m0, s30
    s_add_u32 s30, s30, 1024
    buffer_load_dwordx4 v8, s[8:11], s31 offen lds
    s_add_u32 s31, s31, 16384
    s_lshl_b32 s30, s3, 12
    s_add_u32 s30, s30, 65536
    s_mov_b32 s31, 6656
    s_mov_b32 m0, s30
    s_add_u32 s30, s30, 1024
    buffer_load_dwordx4 v96, s[12:15], s31 offen lds
    s_mov_b32 m0, s30
    s_add_u32 s30, s30, 1024
    buffer_load_dwordx4 v97, s[12:15], s31 offen lds
    s_mov_b32 m0, s30
    s_add_u32 s30, s30, 1024
    buffer_load_dwordx4 v98, s[12:15], s31 offen lds
    s_mov_b32 m0, s30
    s_add_u32 s30, s30, 1024
    buffer_load_dwordx4 v99, s[12:15], s31 offen lds
    v_add_u32 v10, 0x10000, v10
    v_add_u32 v9, 0x10000, v9
    v_xor_b32 v4, 0, v9
    ds_read_b128 v[32:35], v4 offset:32768
    v_xor_b32 v4, 32, v9
    ds_read_b128 v[36:39], v4 offset:32768
    v_xor_b32 v4, 64, v9
    ds_read_b128 v[40:43], v4 offset:32768
    v_xor_b32 v4, 96, v9
    ds_read_b128 v[44:47], v4 offset:32768
    ds_read_b64_tr_b16 v[80:81], v10 offset:32768
    ds_read_b64_tr_b16 v[82:83], v10 offset:33024
    ds_read_b64_tr_b16 v[84:85], v10 offset:33792
    ds_read_b64_tr_b16 v[86:87], v10 offset:34048
    ds_read_b64_tr_b16 v[88:89], v10 offset:34816
    ds_read_b64_tr_b16 v[90:91], v10 offset:35072
    ds_read_b64_tr_b16 v[92:93], v10 offset:35840
    ds_read_b64_tr_b16 v[94:95], v10 offset:36096
    s_waitcnt lgkmcnt(6)
    v_mfma_f32_32x32x16_bf16 v[16:31], v[80:83], v[32:35], v[16:31]
    s_waitcnt lgkmcnt(4)
    v_mfma_f32_32x32x16_bf16 v[16:31], v[84:87], v[36:39], v[16:31]
    s_waitcnt lgkmcnt(2)
    v_mfma_f32_32x32x16_bf16 v[16:31], v[88:91], v[40:43], v[16:31]
    s_waitcnt lgkmcnt(0)
    v_mfma_f32_32x32x16_bf16 v[16:31], v[92:95], v[44:47], v[16:31]
    v_subrev_u32 v10, 0x10000, v10
    v_subrev_u32 v9, 0x10000, v9
    s_waitcnt vmcnt(6)
    s_barrier
    s_lshl_b32 s30, s3, 11
    s_add_u32 s30, s30, 98304
    s_lshl_b32 s31, s3, 15
    s_add_u32 s31, s31, 3670016
    s_mov_b32 m0, s30
    s_add_u32 s30, s30, 1024
    buffer_load_dwordx4 v8, s[8:11], s31 offen lds
    s_add_u32 s31, s31, 16384
    s_mov_b32 m0, s30
    s_add_u32 s30, s30, 1024
    buffer_load_dwordx4 v8, s[8:11], s31 offen lds
    s_add_u32 s31, s31, 16384
    s_lshl_b32 s30, s3, 12
    s_add_u32 s30, s30, 114688
    s_mov_b32 s31, 7168
    s_mov_b32 m0, s30
    s_add_u32 s30, s30, 1024
    buffer_load_dwordx4 v96, s[12:15], s31 offen lds
    s_mov_b32 m0, s30
    s_add_u32 s30, s30, 1024
    buffer_load_dwordx4 v97, s[12:15], s31 offen lds
    s_mov_b32 m0, s30
    s_add_u32 s30, s30, 1024
    buffer_load_dwordx4 v98, s[12:15], s31 offen lds
    s_mov_b32 m0, s30
    s_add_u32 s30, s30, 1024
    buffer_load_dwordx4 v99, s[12:15], s31 offen lds
    v_xor_b32 v4, 0, v9
    ds_read_b128 v[32:35], v4 offset:0
    v_xor_b32 v4, 32, v9
    ds_read_b128 v[36:39], v4 offset:0
    v_xor_b32 v4, 64, v9
    ds_read_b128 v[40:43], v4 offset:0
    v_xor_b32 v4, 96, v9
    ds_read_b128 v[44:47], v4 offset:0
    ds_read_b64_tr_b16 v[80:81], v10 offset:0
    ds_read_b64_tr_b16 v[82:83], v10 offset:256
    ds_read_b64_tr_b16 v[84:85], v10 offset:1024
    ds_read_b64_tr_b16 v[86:87], v10 offset:1280
    ds_read_b64_tr_b16 v[88:89], v10 offset:2048
    ds_read_b64_tr_b16 v[90:91], v10 offset:2304
    ds_read_b64_tr_b16 v[92:93], v10 offset:3072
    ds_read_b64_tr_b16 v[94:95], v10 offset:3328
    s_waitcnt lgkmcnt(6)
    v_mfma_f32_32x32x16_bf16 v[16:31], v[80:83], v[32:35], v[16:31]
    s_waitcnt lgkmcnt(4)
    v_mfma_f32_32x32x16_bf16 v[16:31], v[84:87], v[36:39], v[16:31]
    s_waitcnt lgkmcnt(2)
    v_mfma_f32_32x32x16_bf16 v[16:31], v[88:91], v[40:43], v[16:31]
    s_waitcnt lgkmcnt(0)
    v_mfma_f32_32x32x16_bf16 v[16:31], v[92:95], v[44:47], v[16:31]
    s_waitcnt vmcnt(6)
    s_barrier
    s_lshl_b32 s30, s3, 11
    s_add_u32 s30, s30, 0
    s_lshl_b32 s31, s3, 15
    s_add_u32 s31, s31, 3932160
    s_mov_b32 m0, s30
    s_add_u32 s30, s30, 1024
    buffer_load_dwordx4 v8, s[8:11], s31 offen lds
    s_add_u32 s31, s31, 16384
    s_mov_b32 m0, s30
    s_add_u32 s30, s30, 1024
    buffer_load_dwordx4 v8, s[8:11], s31 offen lds
    s_add_u32 s31, s31, 16384
    s_lshl_b32 s30, s3, 12
    s_add_u32 s30, s30, 16384
    s_mov_b32 s31, 7680
    s_mov_b32 m0, s30
    s_add_u32 s30, s30, 1024
    buffer_load_dwordx4 v96, s[12:15], s31 offen lds
    s_mov_b32 m0, s30
    s_add_u32 s30, s30, 1024
    buffer_load_dwordx4 v97, s[12:15], s31 offen lds
    s_mov_b32 m0, s30
    s_add_u32 s30, s30, 1024
    buffer_load_dwordx4 v98, s[12:15], s31 offen lds
    s_mov_b32 m0, s30
    s_add_u32 s30, s30, 1024
    buffer_load_dwordx4 v99, s[12:15], s31 offen lds
    v_xor_b32 v4, 0, v9
    ds_read_b128 v[32:35], v4 offset:49152
    v_xor_b32 v4, 32, v9
    ds_read_b128 v[36:39], v4 offset:49152
    v_xor_b32 v4, 64, v9
    ds_read_b128 v[40:43], v4 offset:49152
    v_xor_b32 v4, 96, v9
    ds_read_b128 v[44:47], v4 offset:49152
    ds_read_b64_tr_b16 v[80:81], v10 offset:49152
    ds_read_b64_tr_b16 v[82:83], v10 offset:49408
    ds_read_b64_tr_b16 v[84:85], v10 offset:50176
    ds_read_b64_tr_b16 v[86:87], v10 offset:50432
    ds_read_b64_tr_b16 v[88:89], v10 offset:51200
    ds_read_b64_tr_b16 v[90:91], v10 offset:51456
    ds_read_b64_tr_b16 v[92:93], v10 offset:52224
    ds_read_b64_tr_b16 v[94:95], v10 offset:52480
    s_waitcnt lgkmcnt(6)
    v_mfma_f32_32x32x16_bf16 v[16:31], v[80:83], v[32:35], v[16:31]
    s_waitcnt lgkmcnt(4)
    v_mfma_f32_32x32x16_bf16 v[16:31], v[84:87], v[36:39], v[16:31]
    s_waitcnt lgkmcnt(2)
    v_mfma_f32_32x32x16_bf16 v[16:31], v[88:91], v[40:43], v[16:31]
    s_waitcnt lgkmcnt(0)
    v_mfma_f32_32x32x16_bf16 v[16:31], v[92:95], v[44:47], v[16:31]
    s_waitcnt vmcnt(6)
    s_barrier
    v_add_u32 v10, 0x10000, v10
    v_add_u32 v9, 0x10000, v9
    v_xor_b32 v4, 0, v9
    ds_read_b128 v[32:35], v4 offset:32768
    v_xor_b32 v4, 32, v9
    ds_read_b128 v[36:39], v4 offset:32768
    v_xor_b32 v4, 64, v9
    ds_read_b128 v[40:43], v4 offset:32768
    v_xor_b32 v4, 96, v9
    ds_read_b128 v[44:47], v4 offset:32768
    ds_read_b64_tr_b16 v[80:81], v10 offset:32768
    ds_read_b64_tr_b16 v[82:83], v10 offset:33024
    ds_read_b64_tr_b16 v[84:85], v10 offset:33792
    ds_read_b64_tr_b16 v[86:87], v10 offset:34048
    ds_read_b64_tr_b16 v[88:89], v10 offset:34816
    ds_read_b64_tr_b16 v[90:91], v10 offset:35072
    ds_read_b64_tr_b16 v[92:93], v10 offset:35840
    ds_read_b64_tr_b16 v[94:95], v10 offset:36096
    s_waitcnt lgkmcnt(6)
    v_mfma_f32_32x32x16_bf16 v[16:31], v[80:83], v[32:35], v[16:31]
    s_waitcnt lgkmcnt(4)
    v_mfma_f32_32x32x16_bf16 v[16:31], v[84:87], v[36:39], v[16:31]
    s_waitcnt lgkmcnt(2)
    v_mfma_f32_32x32x16_bf16 v[16:31], v[88:91], v[40:43], v[16:31]
    s_waitcnt lgkmcnt(0)
    v_mfma_f32_32x32x16_bf16 v[16:31], v[92:95], v[44:47], v[16:31]
    v_subrev_u32 v10, 0x10000, v10
    v_subrev_u32 v9, 0x10000, v9
    s_waitcnt vmcnt(0)
    s_barrier
    v_xor_b32 v4, 0, v9
    ds_read_b128 v[32:35], v4 offset:0
    v_xor_b32 v4, 32, v9
    ds_read_b128 v[36:39], v4 offset:0
    v_xor_b32 v4, 64, v9
    ds_read_b128 v[40:43], v4 offset:0
    v_xor_b32 v4, 96, v9
    ds_read_b128 v[44:47], v4 offset:0
    ds_read_b64_tr_b16 v[80:81], v10 offset:0
    ds_read_b64_tr_b16 v[82:83], v10 offset:256
    ds_read_b64_tr_b16 v[84:85], v10 offset:1024
    ds_read_b64_tr_b16 v[86:87], v10 offset:1280
    ds_read_b64_tr_b16 v[88:89], v10 offset:2048
    ds_read_b64_tr_b16 v[90:91], v10 offset:2304
    ds_read_b64_tr_b16 v[92:93], v10 offset:3072
    ds_read_b64_tr_b16 v[94:95], v10 offset:3328
    s_waitcnt lgkmcnt(6)
    v_mfma_f32_32x32x16_bf16 v[16:31], v[80:83], v[32:35], v[16:31]
    s_waitcnt lgkmcnt(4)
    v_mfma_f32_32x32x16_bf16 v[16:31], v[84:87], v[36:39], v[16:31]
    s_waitcnt lgkmcnt(2)
    v_mfma_f32_32x32x16_bf16 v[16:31], v[88:91], v[40:43], v[16:31]
    s_waitcnt lgkmcnt(0)
    v_mfma_f32_32x32x16_bf16 v[16:31], v[92:95], v[44:47], v[16:31]
    s_nop 7
    s_nop 7
    s_barrier
    v_lshlrev_b32 v6, 2, v1
    s_mul_i32 s28, s6, 3
    s_add_u32 s28, s28, s7
    s_lshl_b32 s28, s28, 12
    v_add_u32 v6, s28, v6
    s_cmp_eq_u32 s7, 0
    s_cbranch_scc1 L_op_rd
    v_subrev_u32 v6, 4096, v6
    ds_write_b32 v6, v16 offset:0
    ds_write_b32 v6, v17 offset:256
    ds_write_b32 v6, v18 offset:512
    ds_write_b32 v6, v19 offset:768
    ds_write_b32 v6, v20 offset:1024
    ds_write_b32 v6, v21 offset:1280
    ds_write_b32 v6, v22 offset:1536
    ds_write_b32 v6, v23 offset:1792
    ds_write_b32 v6, v24 offset:2048
    ds_write_b32 v6, v25 offset:2304
    ds_write_b32 v6, v26 offset:2560
    ds_write_b32 v6, v27 offset:2816
    ds_write_b32 v6, v28 offset:3072
    ds_write_b32 v6, v29 offset:3328
    ds_write_b32 v6, v30 offset:3584
    ds_write_b32 v6, v31 offset:3840
    s_waitcnt lgkmcnt(0)
    s_barrier
    s_branch L_op_end
L_op_rd:
    s_barrier
    ds_read_b32 v32, v6 offset:0
    ds_read_b32 v33, v6 offset:256
    ds_read_b32 v34, v6 offset:512
    ds_read_b32 v35, v6 offset:768
    ds_read_b32 v36, v6 offset:1024
    ds_read_b32 v37, v6 offset:1280
    ds_read_b32 v38, v6 offset:1536
    ds_read_b32 v39, v6 offset:1792
    ds_read_b32 v40, v6 offset:2048
    ds_read_b32 v41, v6 offset:2304
    ds_read_b32 v42, v6 offset:2560
    ds_read_b32 v43, v6 offset:2816
    ds_read_b32 v44, v6 offset:3072
    ds_read_b32 v45, v6 offset:3328
    ds_read_b32 v46, v6 offset:3584
    ds_read_b32 v47, v6 offset:3840
    s_waitcnt lgkmcnt(0)
    v_add_f32 v16, v16, v32
    v_add_f32 v17, v17, v33
    v_add_f32 v18, v18, v34
    v_add_f32 v19, v19, v35
    v_add_f32 v20, v20, v36
    v_add_f32 v21, v21, v37
    v_add_f32 v22, v22, v38
    v_add_f32 v23, v23, v39
    v_add_f32 v24, v24, v40
    v_add_f32 v25, v25, v41
    v_add_f32 v26, v26, v42
    v_add_f32 v27, v27, v43
    v_add_f32 v28, v28, v44
    v_add_f32 v29, v29, v45
    v_add_f32 v30, v30, v46
    v_add_f32 v31, v31, v47
    ds_read_b32 v32, v6 offset:4096
    ds_read_b32 v33, v6 offset:4352
    ds_read_b32 v34, v6 offset:4608
    ds_read_b32 v35, v6 offset:4864
    ds_read_b32 v36, v6 offset:5120
    ds_read_b32 v37, v6 offset:5376
    ds_read_b32 v38, v6 offset:5632
    ds_read_b32 v39, v6 offset:5888
    ds_read_b32 v40, v6 offset:6144
    ds_read_b32 v41, v6 offset:6400
    ds_read_b32 v42, v6 offset:6656
    ds_read_b32 v43, v6 offset:6912
    ds_read_b32 v44, v6 offset:7168
    ds_read_b32 v45, v6 offset:7424
    ds_read_b32 v46, v6 offset:7680
    ds_read_b32 v47, v6 offset:7936
    s_waitcnt lgkmcnt(0)
    v_add_f32 v16, v16, v32
    v_add_f32 v17, v17, v33
    v_add_f32 v18, v18, v34
    v_add_f32 v19, v19, v35
    v_add_f32 v20, v20, v36
    v_add_f32 v21, v21, v37
    v_add_f32 v22, v22, v38
    v_add_f32 v23, v23, v39
    v_add_f32 v24, v24, v40
    v_add_f32 v25, v25, v41
    v_add_f32 v26, v26, v42
    v_add_f32 v27, v27, v43
    v_add_f32 v28, v28, v44
    v_add_f32 v29, v29, v45
    v_add_f32 v30, v30, v46
    v_add_f32 v31, v31, v47
    ds_read_b32 v32, v6 offset:8192
    ds_read_b32 v33, v6 offset:8448
    ds_read_b32 v34, v6 offset:8704
    ds_read_b32 v35, v6 offset:8960
    ds_read_b32 v36, v6 offset:9216
    ds_read_b32 v37, v6 offset:9472
    ds_read_b32 v38, v6 offset:9728
    ds_read_b32 v39, v6 offset:9984
    ds_read_b32 v40, v6 offset:10240
    ds_read_b32 v41, v6 offset:10496
    ds_read_b32 v42, v6 offset:10752
    ds_read_b32 v43, v6 offset:11008
    ds_read_b32 v44, v6 offset:11264
    ds_read_b32 v45, v6 offset:11520
    ds_read_b32 v46, v6 offset:11776
    ds_read_b32 v47, v6 offset:12032
    s_waitcnt lgkmcnt(0)
    v_add_f32 v16, v16, v32
    v_add_f32 v17, v17, v33
    v_add_f32 v18, v18, v34
    v_add_f32 v19, v19, v35
    v_add_f32 v20, v20, v36
    v_add_f32 v21, v21, v37
    v_add_f32 v22, v22, v38
    v_add_f32 v23, v23, v39
    v_add_f32 v24, v24, v40
    v_add_f32 v25, v25, v41
    v_add_f32 v26, v26, v42
    v_add_f32 v27, v27, v43
    v_add_f32 v28, v28, v44
    v_add_f32 v29, v29, v45
    v_add_f32 v30, v30, v46
    v_add_f32 v31, v31, v47
    s_lshl_b32 s28, s6, 5
    v_add_u32 v5, s28, v2
    v_lshlrev_b32 v5, 10, v5
    v_lshl_add_u32 v5, v3, 3, v5
    v_cvt_pk_bf16_f32 v32, v16, v17
    v_cvt_pk_bf16_f32 v33, v18, v19
    buffer_store_dwordx2 v[32:33], v5, s[16:19], 0 offen offset:0
    v_cvt_pk_bf16_f32 v34, v20, v21
    v_cvt_pk_bf16_f32 v35, v22, v23
    buffer_store_dwordx2 v[34:35], v5, s[16:19], 0 offen offset:16
    v_cvt_pk_bf16_f32 v36, v24, v25
    v_cvt_pk_bf16_f32 v37, v26, v27
    buffer_store_dwordx2 v[36:37], v5, s[16:19], 0 offen offset:32
    v_cvt_pk_bf16_f32 v38, v28, v29
    v_cvt_pk_bf16_f32 v39, v30, v31
    buffer_store_dwordx2 v[38:39], v5, s[16:19], 0 offen offset:48
L_op_end:
    s_endpgm
.section .rodata,"a"
.p2align 6
.amdhsa_kernel attn_fused_kernel
  .amdhsa_next_free_vgpr 256
  .amdhsa_next_free_sgpr 80
  .amdhsa_accum_offset 256
  .amdhsa_group_segment_fixed_size 0
  .amdhsa_kernarg_size 64
  .amdhsa_user_sgpr_count 2
  .amdhsa_user_sgpr_kernarg_segment_ptr 1
  .amdhsa_system_sgpr_workgroup_id_x 1
.end_amdhsa_kernel
.p2align 6
.amdhsa_kernel oproj_kernel
  .amdhsa_next_free_vgpr 128
  .amdhsa_next_free_sgpr 64
  .amdhsa_accum_offset 128
  .amdhsa_group_segment_fixed_size 0
  .amdhsa_kernarg_size 64
  .amdhsa_user_sgpr_count 2
  .amdhsa_user_sgpr_kernarg_segment_ptr 1
  .amdhsa_system_sgpr_workgroup_id_x 1
.end_amdhsa_kernel
```
